```python
import torch

def _softmax(x, axis=-1):
    return torch.softmax(x, dim=axis)

def _gelu(x):
    return torch.nn.functional.gelu(x, approximate='tanh')

def _silu(x):
    return torch.nn.functional.silu(x)

def _sigmoid(x):
    return torch.sigmoid(x)

def _layernorm(x, axis=-1, eps=1e-05):
    m = x.mean(dim=axis, keepdim=True)
    v = x.var(dim=axis, keepdim=True, unbiased=False)
    return (x - m) / torch.sqrt(v + eps)

def _scatter_add(tgt, idx, src, axis=0):
    return tgt.clone().index_add_(axis, idx, src)

def _segment_sum(src, seg, n):
    out = torch.zeros((n,) + src.shape[1:], dtype=src.dtype)
    return out.index_add_(0, seg, src)

def _pad(x, pw):
    flat = tuple((v for pair in reversed(pw) for v in pair))
    return torch.nn.functional.pad(x, flat)
kernel_name = 'standalone__autoregressive_conv_wavernn__speech'

def setup_inputs():

    _w = lambda a: (lambda t: t.to(torch.bfloat16) if t.is_floating_point() else t)(torch.as_tensor(a))
    B, T, D, K = (2, 16000, 144, 31)
    return {'x': _w((lambda *s: torch.randn(*s, dtype=torch.bfloat16) * 0.1)(B, T, D)), 'w': _w((lambda *s: torch.randn(*s, dtype=torch.bfloat16) * 0.1)(K, D, 2 * D))}

def reference(x, w):
    B, T, D = x.shape
    K = w.shape[0]
    dil = 2
    pad = (K - 1) * dil
    xp = _pad(x, ((0, 0), (pad, 0), (0, 0)))
    h = torch.einsum('btd,de->bte', xp[:, 0:T, :], w[0])
    for i in range(1, K):
        h = h + torch.einsum('btd,de->bte', xp[:, i * dil:i * dil + T, :], w[i])
    f, g = (h[..., :D].clone(), h[..., D:].clone())
    return torch.tanh(f) * _sigmoid(g)
```

```asm
; @launch grid=(256,1,1) block=(256,1,1) lds=163840
.amdgcn_target "amdgcn-amd-amdhsa--gfx950"
.text
.globl standalone__autoregressive_conv_wavernn__speech_kernel
.p2align 8
.type standalone__autoregressive_conv_wavernn__speech_kernel,@function
standalone__autoregressive_conv_wavernn__speech_kernel:
    s_cmp_ge_u32 s2, 256
    s_cbranch_scc1 L_end_standalone__autoregressive_conv_wavernn__speech_kernel
    s_load_dwordx4 s[4:7], s[0:1], 0
    s_load_dwordx4 s[52:55], s[0:1], 16
    s_load_dwordx2 s[8:9], s[0:1], 32
    v_and_b32 v1, 63, v0
    v_lshrrev_b32 v2, 6, v0
    s_and_b32 s21, s2, 7
    v_readfirstlane_b32 s20, v2
    s_lshr_b32 s22, s2, 3
    s_getpc_b64 s[60:61]
L_pc_standalone__autoregressive_conv_wavernn__speech_kernel:
    s_add_u32 s60, s60, standalone__autoregressive_conv_wavernn__speech_kernel-L_pc_standalone__autoregressive_conv_wavernn__speech_kernel
    s_addc_u32 s61, s61, -1
    s_lshl_b32 s62, s22, 10
    v_lshl_add_u32 v158, v0, 2, s62
    v_min_u32 v158, L_end_standalone__autoregressive_conv_wavernn__speech_kernel-standalone__autoregressive_conv_wavernn__speech_kernel, v158
    v_mov_b32 v159, s61
    v_add_co_u32 v158, vcc, s60, v158
    v_lshlrev_b32 v2, 4, v1
    s_nop 0
    v_addc_co_u32 v159, vcc, 0, v159, vcc
    global_load_dword v158, v[158:159], off
    s_lshl_b32 s36, s21, 3
    s_lshr_b32 s37, s22, 2
    s_add_u32 s36, s36, s37
    s_and_b32 s37, s22, 3
    s_mov_b32 s67, 0
    s_mul_i32 s23, s21, 21
    s_add_u32 s23, s23, s22
    s_sub_u32 s3, s2, 168
    s_mul_i32 s28, s3, 4
    s_add_u32 s28, s28, 0
    s_cmp_lt_u32 s3, 81
    s_cselect_b32 s29, 4, 0
    s_cmp_lt_u32 s22, 21
    s_cselect_b32 s28, s23, s28
    s_cselect_b32 s29, 0, s29
    s_cselect_b32 s63, 1, 0
    v_lshrrev_b32 v8, 4, v1
    v_mul_u32_u24 v3, 576, v8
    v_and_b32 v8, 3, v1
    v_lshl_add_u32 v3, v8, 4, v3
    v_bfe_u32 v8, v1, 2, 2
    s_lshl_b32 s3, s20, 3
    v_add_u32 v8, s3, v8
    v_mul_u32_u24 v8, 82944, v8
    v_add_u32 v3, v3, v8
    s_lshl_b32 s30, s20, 11
    s_add_u32 s30, s30, 98304
    s_mov_b32 s31, s28
    s_add_u32 s32, s28, s29
    v_mov_b32 v12, 0x80000000
    s_waitcnt lgkmcnt(0)
    s_mov_b32 s24, s6
    s_mov_b32 s25, s7
    s_mov_b32 s26, 2571264
    s_mov_b32 s27, 0x00020000
    s_mov_b32 s12, s8
    s_mov_b32 s13, s9
    s_mov_b32 s14, 268435456
    s_mov_b32 s15, 0x00020000
    s_cmp_eq_u32 s29, 0
    s_cbranch_scc1 L_nowdma
L_wdma:
    s_mul_i32 s33, s31, 7282
    s_lshr_b32 s33, s33, 16
    s_mul_i32 s34, s33, 1728
    s_lshl_b32 s35, s31, 6
    s_add_u32 s34, s34, s35
    s_mov_b32 m0, s30
    v_add_u32 v8, s34, v3
    v_add_u32 v9, 330752, v8
    buffer_load_dwordx4 v8, s[24:27], 0 offen nt lds
    buffer_load_dwordx4 v9, s[24:27], 0 offen offset:1024 nt lds
    s_add_u32 s30, s30, 8192
    s_add_u32 s31, s31, 1
    s_cmp_lt_u32 s31, s32
    s_cbranch_scc1 L_wdma
L_nowdma:
    s_cmp_eq_u32 s63, 0
    s_cbranch_scc1 L_nox1
    s_cmp_ge_u32 s23, 84
    s_cselect_b32 s33, 4608000, 0
    s_cselect_b32 s34, 84, 0
    s_sub_u32 s34, s23, s34
    s_mov_b32 s18, 4608000
    s_mov_b32 s19, 0x00020000
    s_mul_i32 s34, s34, 55296
    s_sub_u32 s34, s34, 18432
    s_mul_i32 s35, s20, 18432
    s_add_u32 s34, s34, s35
    s_mul_i32 s35, s20, 18496
    s_mov_b32 m0, s35
    v_add_u32 v10, s34, v2
    s_add_u32 s16, s4, s33
    s_addc_u32 s17, s5, 0
    buffer_load_dwordx4 v10, s[16:19], 0 offen  lds
    s_add_u32 m0, m0, 1024
    v_add_u32 v10, 1024, v10
    buffer_load_dwordx4 v10, s[16:19], 0 offen  lds
    s_add_u32 m0, m0, 1024
    v_add_u32 v10, 1024, v10
    buffer_load_dwordx4 v10, s[16:19], 0 offen  lds
    s_add_u32 m0, m0, 1024
    v_add_u32 v10, 1024, v10
    buffer_load_dwordx4 v10, s[16:19], 0 offen  lds
    s_add_u32 m0, m0, 1024
    v_add_u32 v10, 1024, v10
    buffer_load_dwordx4 v10, s[16:19], 0 offen  lds
    s_add_u32 m0, m0, 1024
    v_add_u32 v10, 1024, v10
    buffer_load_dwordx4 v10, s[16:19], 0 offen  lds
    s_add_u32 m0, m0, 1024
    v_add_u32 v10, 1024, v10
    buffer_load_dwordx4 v10, s[16:19], 0 offen  lds
    s_add_u32 m0, m0, 1024
    v_add_u32 v10, 1024, v10
    buffer_load_dwordx4 v10, s[16:19], 0 offen  lds
    s_add_u32 m0, m0, 1024
    v_add_u32 v10, 1024, v10
    buffer_load_dwordx4 v10, s[16:19], 0 offen  lds
    s_add_u32 m0, m0, 1024
    v_add_u32 v10, 1024, v10
    s_branch L_rows
L_nox1:
    s_cmp_lg_u32 s2, 249
    s_cbranch_scc1 L_norace
    s_mov_b32 s56, s54
    s_mov_b32 s57, s55
    s_mov_b32 s58, 256
    s_mov_b32 s59, 0x00020000
    v_lshlrev_b32 v8, 2, v1
    v_add_u32 v8, 58720256, v8
    v_mov_b32 v9, 0
    s_cmp_lg_u32 s20, 0
    s_cbranch_scc1 L_nowarm
    buffer_store_dword v9, v8, s[12:15], 0 offen sc1
L_nowarm:
    s_waitcnt vmcnt(0)
    s_barrier
    s_cmp_lg_u32 s20, 0
    s_cbranch_scc1 L_rows
    s_mov_b32 exec_hi, 0
    s_mov_b32 s33, 0
    s_memtime s[40:41]
    s_mov_b32 s3, 33024
    s_waitcnt lgkmcnt(0)
    buffer_store_dword v9, v8, s[12:15], s3 offen sc1
    s_waitcnt vmcnt(0)
    s_memtime s[42:43]
    s_mov_b32 s3, 41216
    s_waitcnt lgkmcnt(0)
    buffer_store_dword v9, v8, s[12:15], s3 offen sc1
    s_waitcnt vmcnt(0)
    s_memtime s[44:45]
    s_waitcnt lgkmcnt(0)
    s_sub_u32 s34, s42, s40
    s_sub_u32 s35, s44, s42
    s_cmp_gt_u32 s34, s35
    s_addc_u32 s33, s33, 0
    s_memtime s[40:41]
    s_mov_b32 s3, 78336
    s_waitcnt lgkmcnt(0)
    buffer_store_dword v9, v8, s[12:15], s3 offen sc1
    s_waitcnt vmcnt(0)
    s_memtime s[42:43]
    s_mov_b32 s3, 70144
    s_waitcnt lgkmcnt(0)
    buffer_store_dword v9, v8, s[12:15], s3 offen sc1
    s_waitcnt vmcnt(0)
    s_memtime s[44:45]
    s_waitcnt lgkmcnt(0)
    s_sub_u32 s34, s42, s40
    s_sub_u32 s35, s44, s42
    s_cmp_gt_u32 s35, s34
    s_addc_u32 s33, s33, 0
    s_memtime s[40:41]
    s_mov_b32 s3, 115456
    s_waitcnt lgkmcnt(0)
    buffer_store_dword v9, v8, s[12:15], s3 offen sc1
    s_waitcnt vmcnt(0)
    s_memtime s[42:43]
    s_mov_b32 s3, 123648
    s_waitcnt lgkmcnt(0)
    buffer_store_dword v9, v8, s[12:15], s3 offen sc1
    s_waitcnt vmcnt(0)
    s_memtime s[44:45]
    s_waitcnt lgkmcnt(0)
    s_sub_u32 s34, s42, s40
    s_sub_u32 s35, s44, s42
    s_cmp_gt_u32 s34, s35
    s_addc_u32 s33, s33, 0
    s_memtime s[40:41]
    s_mov_b32 s3, 160768
    s_waitcnt lgkmcnt(0)
    buffer_store_dword v9, v8, s[12:15], s3 offen sc1
    s_waitcnt vmcnt(0)
    s_memtime s[42:43]
    s_mov_b32 s3, 152576
    s_waitcnt lgkmcnt(0)
    buffer_store_dword v9, v8, s[12:15], s3 offen sc1
    s_waitcnt vmcnt(0)
    s_memtime s[44:45]
    s_waitcnt lgkmcnt(0)
    s_sub_u32 s34, s42, s40
    s_sub_u32 s35, s44, s42
    s_cmp_gt_u32 s35, s34
    s_addc_u32 s33, s33, 0
    s_memtime s[40:41]
    s_mov_b32 s3, 165120
    s_waitcnt lgkmcnt(0)
    buffer_store_dword v9, v8, s[12:15], s3 offen sc1
    s_waitcnt vmcnt(0)
    s_memtime s[42:43]
    s_mov_b32 s3, 173312
    s_waitcnt lgkmcnt(0)
    buffer_store_dword v9, v8, s[12:15], s3 offen sc1
    s_waitcnt vmcnt(0)
    s_memtime s[44:45]
    s_waitcnt lgkmcnt(0)
    s_sub_u32 s34, s42, s40
    s_sub_u32 s35, s44, s42
    s_cmp_gt_u32 s34, s35
    s_addc_u32 s33, s33, 0
    s_getreg_b32 s35, hwreg(HW_REG_XCC_ID, 0, 3)
    s_and_b32 s34, s35, 4
    s_xor_b32 s3, s34, 4
    s_cmp_le_u32 s33, 2
    s_cselect_b32 s34, s34, 2
    s_cmp_ge_u32 s33, 3
    s_cselect_b32 s34, s3, s34
    s_sub_u32 s35, s35, s21
    s_add_u32 s35, s35, s34
    s_and_b32 s35, s35, 7
    s_bitset1_b32 s35, 31
    v_mov_b32 v8, s35
    v_mov_b32 v10, 16
    s_mov_b32 exec_lo, 1
    buffer_store_dword v8, v10, s[56:59], 0 offen sc1
    s_mov_b64 exec, -1
    s_branch L_rows
L_norace:
    s_cmp_lt_u32 s2, 252
    s_cbranch_scc1 L_rows
    s_mov_b32 s56, s54
    s_mov_b32 s57, s55
    s_mov_b32 s58, 256
    s_mov_b32 s59, 0x00020000
    s_and_b32 s33, s2, 3
    s_lshl_b32 s3, s33, 15
    s_add_u32 s3, s3, 54525952
    v_lshl_add_u32 v8, v0, 7, s3
    v_mov_b32 v9, 0
    buffer_load_dword v20, v8, s[12:15], 0 offen sc1
    buffer_load_dword v24, v9, s[56:59], 0 offen sc1
    v_mov_b32 v16, 0
    v_mov_b32 v17, 0
    v_lshlrev_b32 v10, 3, v0
    v_mov_b32 v25, -1
    ds_write_b64 v10, v[16:17]
    ds_write_b32 v9, v25 offset:2048
    s_waitcnt vmcnt(0) lgkmcnt(0)
    s_barrier
    v_and_b32 v20, 511, v20
    v_lshlrev_b32 v20, 2, v20
    ds_write_b32 v20, v25
    s_waitcnt lgkmcnt(0)
    s_barrier
    ds_read_b64 v[16:17], v10
    v_lshlrev_b32 v11, 1, v0
    s_waitcnt lgkmcnt(0)
    v_or_b32 v16, v16, v11
    v_or3_b32 v17, v17, v11, 1
    v_min_u32 v16, v16, v17
    ds_min_u32 v9, v16 offset:2048
    s_waitcnt lgkmcnt(0)
    s_barrier
    s_cmp_lg_u32 s20, 0
    s_cbranch_scc1 L_rows
    ds_read_b32 v8, v9 offset:2048
    s_lshl_b32 s33, s33, 2
    v_mov_b32 v10, s33
    s_waitcnt lgkmcnt(0)
    v_or_b32 v8, 0x80000000, v8
    s_mov_b64 exec, 1
    buffer_store_dword v8, v10, s[56:59], 0 offen sc1
    s_mov_b64 exec, -1
L_rows:
    v_and_b32 v6, 30, v1
    v_or_b32 v6, 1, v6
    s_lshl_b32 s3, s20, 5
    s_and_b32 s33, s3, 32
    s_cmp_eq_u32 s63, 1
    s_cselect_b32 s3, s33, s3
    v_add_u32 v6, s3, v6
    v_cvt_f32_u32 v6, v6
    v_mul_f32 v6, 0x3b800000, v6
    v_lshrrev_b32 v9, 5, v1
    v_lshlrev_b32 v7, 3, v9
    v_cvt_f32_u32 v7, v7
    v_mul_f32 v7, v7, v6
    v_and_b32 v8, 1, v1
    v_cvt_f32_u32 v8, v8
    v_fmac_f32 v7, 0x3e800000, v8
    s_cmp_eq_u32 s63, 0
    s_cbranch_scc1 L_wrows
    v_fmamk_f32 v144, v6, 0x00000000, v7
    v_fmamk_f32 v145, v6, 0x40000000, v7
    v_fmamk_f32 v146, v6, 0x42000000, v7
    v_fmamk_f32 v147, v6, 0x42080000, v7
    v_fmamk_f32 v148, v6, 0x40800000, v7
    v_fmamk_f32 v149, v6, 0x40c00000, v7
    v_fmamk_f32 v150, v6, 0x42100000, v7
    v_fmamk_f32 v151, v6, 0x42180000, v7
    v_fract_f32 v144, v144
    v_fract_f32 v145, v145
    v_fract_f32 v146, v146
    v_fract_f32 v147, v147
    v_fract_f32 v148, v148
    v_fract_f32 v149, v149
    v_fract_f32 v150, v150
    v_fract_f32 v151, v151
    v_cos_f32 v144, v144
    v_cos_f32 v145, v145
    v_cos_f32 v146, v146
    v_cos_f32 v147, v147
    v_cos_f32 v148, v148
    v_cos_f32 v149, v149
    v_cos_f32 v150, v150
    v_cos_f32 v151, v151
    v_cvt_pk_bf16_f32 v16, v144, v145
    v_cvt_pk_bf16_f32 v17, v146, v147
    v_cvt_pk_bf16_f32 v18, v148, v149
    v_cvt_pk_bf16_f32 v19, v150, v151
    v_fmamk_f32 v144, v6, 0x41800000, v7
    v_fmamk_f32 v145, v6, 0x41900000, v7
    v_fmamk_f32 v146, v6, 0x42400000, v7
    v_fmamk_f32 v147, v6, 0x42480000, v7
    v_fmamk_f32 v148, v6, 0x41a00000, v7
    v_fmamk_f32 v149, v6, 0x41b00000, v7
    v_fmamk_f32 v150, v6, 0x42500000, v7
    v_fmamk_f32 v151, v6, 0x42580000, v7
    v_fract_f32 v144, v144
    v_fract_f32 v145, v145
    v_fract_f32 v146, v146
    v_fract_f32 v147, v147
    v_fract_f32 v148, v148
    v_fract_f32 v149, v149
    v_fract_f32 v150, v150
    v_fract_f32 v151, v151
    v_cos_f32 v144, v144
    v_cos_f32 v145, v145
    v_cos_f32 v146, v146
    v_cos_f32 v147, v147
    v_cos_f32 v148, v148
    v_cos_f32 v149, v149
    v_cos_f32 v150, v150
    v_cos_f32 v151, v151
    v_cvt_pk_bf16_f32 v20, v144, v145
    v_cvt_pk_bf16_f32 v21, v146, v147
    v_cvt_pk_bf16_f32 v22, v148, v149
    v_cvt_pk_bf16_f32 v23, v150, v151
    v_fmamk_f32 v144, v6, 0x42800000, v7
    v_fmamk_f32 v145, v6, 0x42840000, v7
    v_fmamk_f32 v146, v6, 0x42c00000, v7
    v_fmamk_f32 v147, v6, 0x42c40000, v7
    v_fmamk_f32 v148, v6, 0x42880000, v7
    v_fmamk_f32 v149, v6, 0x428c0000, v7
    v_fmamk_f32 v150, v6, 0x42c80000, v7
    v_fmamk_f32 v151, v6, 0x42cc0000, v7
    v_fract_f32 v144, v144
    v_fract_f32 v145, v145
    v_fract_f32 v146, v146
    v_fract_f32 v147, v147
    v_fract_f32 v148, v148
    v_fract_f32 v149, v149
    v_fract_f32 v150, v150
    v_fract_f32 v151, v151
    v_cos_f32 v144, v144
    v_cos_f32 v145, v145
    v_cos_f32 v146, v146
    v_cos_f32 v147, v147
    v_cos_f32 v148, v148
    v_cos_f32 v149, v149
    v_cos_f32 v150, v150
    v_cos_f32 v151, v151
    v_cvt_pk_bf16_f32 v24, v144, v145
    v_cvt_pk_bf16_f32 v25, v146, v147
    v_cvt_pk_bf16_f32 v26, v148, v149
    v_cvt_pk_bf16_f32 v27, v150, v151
    v_fmamk_f32 v144, v6, 0x42a00000, v7
    v_fmamk_f32 v145, v6, 0x42a40000, v7
    v_fmamk_f32 v146, v6, 0x42e00000, v7
    v_fmamk_f32 v147, v6, 0x42e40000, v7
    v_fmamk_f32 v148, v6, 0x42a80000, v7
    v_fmamk_f32 v149, v6, 0x42ac0000, v7
    v_fmamk_f32 v150, v6, 0x42e80000, v7
    v_fmamk_f32 v151, v6, 0x42ec0000, v7
    v_fract_f32 v144, v144
    v_fract_f32 v145, v145
    v_fract_f32 v146, v146
    v_fract_f32 v147, v147
    v_fract_f32 v148, v148
    v_fract_f32 v149, v149
    v_fract_f32 v150, v150
    v_fract_f32 v151, v151
    v_cos_f32 v144, v144
    v_cos_f32 v145, v145
    v_cos_f32 v146, v146
    v_cos_f32 v147, v147
    v_cos_f32 v148, v148
    v_cos_f32 v149, v149
    v_cos_f32 v150, v150
    v_cos_f32 v151, v151
    v_cvt_pk_bf16_f32 v28, v144, v145
    v_cvt_pk_bf16_f32 v29, v146, v147
    v_cvt_pk_bf16_f32 v30, v148, v149
    v_cvt_pk_bf16_f32 v31, v150, v151
    v_fmamk_f32 v144, v6, 0x3f800000, v7
    v_fmamk_f32 v145, v6, 0x40400000, v7
    v_fmamk_f32 v146, v6, 0x42040000, v7
    v_fmamk_f32 v147, v6, 0x420c0000, v7
    v_fmamk_f32 v148, v6, 0x40a00000, v7
    v_fmamk_f32 v149, v6, 0x40e00000, v7
    v_fmamk_f32 v150, v6, 0x42140000, v7
    v_fmamk_f32 v151, v6, 0x421c0000, v7
    v_fract_f32 v144, v144
    v_fract_f32 v145, v145
    v_fract_f32 v146, v146
    v_fract_f32 v147, v147
    v_fract_f32 v148, v148
    v_fract_f32 v149, v149
    v_fract_f32 v150, v150
    v_fract_f32 v151, v151
    v_cos_f32 v144, v144
    v_cos_f32 v145, v145
    v_cos_f32 v146, v146
    v_cos_f32 v147, v147
    v_cos_f32 v148, v148
    v_cos_f32 v149, v149
    v_cos_f32 v150, v150
    v_cos_f32 v151, v151
    v_cvt_pk_bf16_f32 v32, v144, v145
    v_cvt_pk_bf16_f32 v33, v146, v147
    v_cvt_pk_bf16_f32 v34, v148, v149
    v_cvt_pk_bf16_f32 v35, v150, v151
    v_fmamk_f32 v144, v6, 0x41880000, v7
    v_fmamk_f32 v145, v6, 0x41980000, v7
    v_fmamk_f32 v146, v6, 0x42440000, v7
    v_fmamk_f32 v147, v6, 0x424c0000, v7
    v_fmamk_f32 v148, v6, 0x41a80000, v7
    v_fmamk_f32 v149, v6, 0x41b80000, v7
    v_fmamk_f32 v150, v6, 0x42540000, v7
    v_fmamk_f32 v151, v6, 0x425c0000, v7
    v_fract_f32 v144, v144
    v_fract_f32 v145, v145
    v_fract_f32 v146, v146
    v_fract_f32 v147, v147
    v_fract_f32 v148, v148
    v_fract_f32 v149, v149
    v_fract_f32 v150, v150
    v_fract_f32 v151, v151
    v_cos_f32 v144, v144
    v_cos_f32 v145, v145
    v_cos_f32 v146, v146
    v_cos_f32 v147, v147
    v_cos_f32 v148, v148
    v_cos_f32 v149, v149
    v_cos_f32 v150, v150
    v_cos_f32 v151, v151
    v_cvt_pk_bf16_f32 v36, v144, v145
    v_cvt_pk_bf16_f32 v37, v146, v147
    v_cvt_pk_bf16_f32 v38, v148, v149
    v_cvt_pk_bf16_f32 v39, v150, v151
    v_fmamk_f32 v144, v6, 0x42820000, v7
    v_fmamk_f32 v145, v6, 0x42860000, v7
    v_fmamk_f32 v146, v6, 0x42c20000, v7
    v_fmamk_f32 v147, v6, 0x42c60000, v7
    v_fmamk_f32 v148, v6, 0x428a0000, v7
    v_fmamk_f32 v149, v6, 0x428e0000, v7
    v_fmamk_f32 v150, v6, 0x42ca0000, v7
    v_fmamk_f32 v151, v6, 0x42ce0000, v7
    v_fract_f32 v144, v144
    v_fract_f32 v145, v145
    v_fract_f32 v146, v146
    v_fract_f32 v147, v147
    v_fract_f32 v148, v148
    v_fract_f32 v149, v149
    v_fract_f32 v150, v150
    v_fract_f32 v151, v151
    v_cos_f32 v144, v144
    v_cos_f32 v145, v145
    v_cos_f32 v146, v146
    v_cos_f32 v147, v147
    v_cos_f32 v148, v148
    v_cos_f32 v149, v149
    v_cos_f32 v150, v150
    v_cos_f32 v151, v151
    v_cvt_pk_bf16_f32 v40, v144, v145
    v_cvt_pk_bf16_f32 v41, v146, v147
    v_cvt_pk_bf16_f32 v42, v148, v149
    v_cvt_pk_bf16_f32 v43, v150, v151
    v_fmamk_f32 v144, v6, 0x42a20000, v7
    v_fmamk_f32 v145, v6, 0x42a60000, v7
    v_fmamk_f32 v146, v6, 0x42e20000, v7
    v_fmamk_f32 v147, v6, 0x42e60000, v7
    v_fmamk_f32 v148, v6, 0x42aa0000, v7
    v_fmamk_f32 v149, v6, 0x42ae0000, v7
    v_fmamk_f32 v150, v6, 0x42ea0000, v7
    v_fmamk_f32 v151, v6, 0x42ee0000, v7
    v_fract_f32 v144, v144
    v_fract_f32 v145, v145
    v_fract_f32 v146, v146
    v_fract_f32 v147, v147
    v_fract_f32 v148, v148
    v_fract_f32 v149, v149
    v_fract_f32 v150, v150
    v_fract_f32 v151, v151
    v_cos_f32 v144, v144
    v_cos_f32 v145, v145
    v_cos_f32 v146, v146
    v_cos_f32 v147, v147
    v_cos_f32 v148, v148
    v_cos_f32 v149, v149
    v_cos_f32 v150, v150
    v_cos_f32 v151, v151
    v_cvt_pk_bf16_f32 v44, v144, v145
    v_cvt_pk_bf16_f32 v45, v146, v147
    v_cvt_pk_bf16_f32 v46, v148, v149
    v_cvt_pk_bf16_f32 v47, v150, v151
    buffer_load_dwordx4 v10, s[16:19], 0 offen  lds
    s_add_u32 m0, m0, 1024
    v_add_u32 v10, 1024, v10
    buffer_load_dwordx4 v10, s[16:19], 0 offen  lds
    s_add_u32 m0, m0, 1024
    v_add_u32 v10, 1024, v10
    buffer_load_dwordx4 v10, s[16:19], 0 offen  lds
    s_add_u32 m0, m0, 1024
    v_add_u32 v10, 1024, v10
    buffer_load_dwordx4 v10, s[16:19], 0 offen  lds
    s_add_u32 m0, m0, 1024
    v_add_u32 v10, 1024, v10
    buffer_load_dwordx4 v10, s[16:19], 0 offen  lds
    s_add_u32 m0, m0, 1024
    v_add_u32 v10, 1024, v10
    buffer_load_dwordx4 v10, s[16:19], 0 offen  lds
    s_add_u32 m0, m0, 1024
    v_add_u32 v10, 1024, v10
    buffer_load_dwordx4 v10, s[16:19], 0 offen  lds
    s_add_u32 m0, m0, 1024
    v_add_u32 v10, 1024, v10
    buffer_load_dwordx4 v10, s[16:19], 0 offen  lds
    s_add_u32 m0, m0, 1024
    v_add_u32 v10, 1024, v10
    buffer_load_dwordx4 v10, s[16:19], 0 offen  lds
    s_branch L_xgo
L_wrows:
    v_fmamk_f32 v144, v6, 0x00000000, v7
    v_fmamk_f32 v145, v6, 0x3f800000, v7
    v_fmamk_f32 v146, v6, 0x40000000, v7
    v_fmamk_f32 v147, v6, 0x40400000, v7
    v_fmamk_f32 v148, v6, 0x40800000, v7
    v_fmamk_f32 v149, v6, 0x40a00000, v7
    v_fmamk_f32 v150, v6, 0x40c00000, v7
    v_fmamk_f32 v151, v6, 0x40e00000, v7
    v_fract_f32 v144, v144
    v_fract_f32 v145, v145
    v_fract_f32 v146, v146
    v_fract_f32 v147, v147
    v_fract_f32 v148, v148
    v_fract_f32 v149, v149
    v_fract_f32 v150, v150
    v_fract_f32 v151, v151
    v_cos_f32 v144, v144
    v_cos_f32 v145, v145
    v_cos_f32 v146, v146
    v_cos_f32 v147, v147
    v_cos_f32 v148, v148
    v_cos_f32 v149, v149
    v_cos_f32 v150, v150
    v_cos_f32 v151, v151
    v_cvt_pk_bf16_f32 v16, v144, v145
    v_cvt_pk_bf16_f32 v17, v146, v147
    v_cvt_pk_bf16_f32 v18, v148, v149
    v_cvt_pk_bf16_f32 v19, v150, v151
    v_fmamk_f32 v144, v6, 0x41800000, v7
    v_fmamk_f32 v145, v6, 0x41880000, v7
    v_fmamk_f32 v146, v6, 0x41900000, v7
    v_fmamk_f32 v147, v6, 0x41980000, v7
    v_fmamk_f32 v148, v6, 0x41a00000, v7
    v_fmamk_f32 v149, v6, 0x41a80000, v7
    v_fmamk_f32 v150, v6, 0x41b00000, v7
    v_fmamk_f32 v151, v6, 0x41b80000, v7
    v_fract_f32 v144, v144
    v_fract_f32 v145, v145
    v_fract_f32 v146, v146
    v_fract_f32 v147, v147
    v_fract_f32 v148, v148
    v_fract_f32 v149, v149
    v_fract_f32 v150, v150
    v_fract_f32 v151, v151
    v_cos_f32 v144, v144
    v_cos_f32 v145, v145
    v_cos_f32 v146, v146
    v_cos_f32 v147, v147
    v_cos_f32 v148, v148
    v_cos_f32 v149, v149
    v_cos_f32 v150, v150
    v_cos_f32 v151, v151
    v_cvt_pk_bf16_f32 v20, v144, v145
    v_cvt_pk_bf16_f32 v21, v146, v147
    v_cvt_pk_bf16_f32 v22, v148, v149
    v_cvt_pk_bf16_f32 v23, v150, v151
    v_bfe_u32 v8, v1, 2, 2
    v_lshlrev_b32 v4, 6, v8
    v_lshl_add_u32 v4, v9, 11, v4
    v_bfe_u32 v11, v1, 4, 1
    v_lshl_add_u32 v4, v11, 5, v4
    v_and_b32 v8, 1, v1
    v_lshl_add_u32 v4, v8, 4, v4
    v_bfe_u32 v8, v1, 1, 1
    v_lshl_add_u32 v4, v8, 3, v4
    v_add_u32 v4, 98304, v4
    s_and_b32 s3, s20, 1
    s_lshl_b32 s3, s3, 18
    s_lshr_b32 s33, s20, 1
    s_lshl_b32 s33, s33, 13
    s_add_u32 s3, s3, s33
    s_add_u32 s3, s3, 16777216
    v_and_b32 v5, 15, v1
    v_lshlrev_b32 v5, 4, v5
    v_mul_u32_u24 v8, 32768, v9
    v_add3_u32 v5, v5, v8, s3
    s_mov_b32 s41, 16384
    s_mov_b32 s42, 65536
    s_mov_b32 s43, 81920
    s_mov_b32 s44, 131072
    s_mov_b32 s45, 147456
    s_mov_b32 s46, 196608
    s_mov_b32 s47, 212992
    v_lshrrev_b32 v9, 5, v1
    v_lshlrev_b32 v8, 1, v9
    s_lshl_b32 s3, s20, 5
    s_add_u32 s3, s3, 1
    v_add_u32 v8, s3, v8
    v_cvt_f32_u32 v152, v8
    v_add_f32 v153, 0x41800000, v152
    v_and_b32 v8, 31, v1
    v_add_u32 v8, 2, v8
    v_cvt_f32_u32 v154, v8
    v_mul_f32 v154, 0x3b800000, v154
    s_lshl_b32 s3, s20, 11
    s_add_u32 s3, s3, 73728
    v_add_u32 v8, s3, v2
    v_add_u32 v15, 73728, v2
    s_mov_b32 s33, 0xbcb8aa3b
    s_mov_b32 s34, 0x3cb8aa3b
    v_mul_f32 v155, 4.0, v154
    v_mul_f32 v144, v152, v154
    v_add_f32 v146, v144, v155
    v_add_f32 v148, v146, v155
    v_add_f32 v150, v148, v155
    v_fract_f32 v144, v144
    v_fract_f32 v146, v146
    v_fract_f32 v148, v148
    v_fract_f32 v150, v150
    v_sin_f32 v145, v144
    v_cos_f32 v144, v144
    v_sin_f32 v147, v146
    v_cos_f32 v146, v146
    v_sin_f32 v149, v148
    v_cos_f32 v148, v148
    v_sin_f32 v151, v150
    v_cos_f32 v150, v150
    v_mul_f32 v145, s34, v145
    v_mul_f32 v144, s33, v144
    v_mul_f32 v147, s34, v147
    v_mul_f32 v146, s33, v146
    v_mul_f32 v149, s34, v149
    v_mul_f32 v148, s33, v148
    v_mul_f32 v151, s34, v151
    v_mul_f32 v150, s33, v150
    v_cvt_pk_bf16_f32 v80, v144, v145
    v_cvt_pk_bf16_f32 v81, v146, v147
    v_cvt_pk_bf16_f32 v82, v148, v149
    v_cvt_pk_bf16_f32 v83, v150, v151
    ds_write_b128 v8, v[80:83] offset:0
    v_mul_f32 v144, v153, v154
    v_add_f32 v146, v144, v155
    v_add_f32 v148, v146, v155
    v_add_f32 v150, v148, v155
    v_fract_f32 v144, v144
    v_fract_f32 v146, v146
    v_fract_f32 v148, v148
    v_fract_f32 v150, v150
    v_sin_f32 v145, v144
    v_cos_f32 v144, v144
    v_sin_f32 v147, v146
    v_cos_f32 v146, v146
    v_sin_f32 v149, v148
    v_cos_f32 v148, v148
    v_sin_f32 v151, v150
    v_cos_f32 v150, v150
    v_mul_f32 v145, s34, v145
    v_mul_f32 v144, s33, v144
    v_mul_f32 v147, s34, v147
    v_mul_f32 v146, s33, v146
    v_mul_f32 v149, s34, v149
    v_mul_f32 v148, s33, v148
    v_mul_f32 v151, s34, v151
    v_mul_f32 v150, s33, v150
    v_cvt_pk_bf16_f32 v84, v144, v145
    v_cvt_pk_bf16_f32 v85, v146, v147
    v_cvt_pk_bf16_f32 v86, v148, v149
    v_cvt_pk_bf16_f32 v87, v150, v151
    ds_write_b128 v8, v[84:87] offset:1024
    v_add_f32 v154, 0x3e000000, v154
    v_mul_f32 v155, 4.0, v154
    v_mul_f32 v144, v152, v154
    v_add_f32 v146, v144, v155
    v_add_f32 v148, v146, v155
    v_add_f32 v150, v148, v155
    v_fract_f32 v144, v144
    v_fract_f32 v146, v146
    v_fract_f32 v148, v148
    v_fract_f32 v150, v150
    v_sin_f32 v145, v144
    v_cos_f32 v144, v144
    v_sin_f32 v147, v146
    v_cos_f32 v146, v146
    v_sin_f32 v149, v148
    v_cos_f32 v148, v148
    v_sin_f32 v151, v150
    v_cos_f32 v150, v150
    v_mul_f32 v145, s34, v145
    v_mul_f32 v144, s33, v144
    v_mul_f32 v147, s34, v147
    v_mul_f32 v146, s33, v146
    v_mul_f32 v149, s34, v149
    v_mul_f32 v148, s33, v148
    v_mul_f32 v151, s34, v151
    v_mul_f32 v150, s33, v150
    v_cvt_pk_bf16_f32 v88, v144, v145
    v_cvt_pk_bf16_f32 v89, v146, v147
    v_cvt_pk_bf16_f32 v90, v148, v149
    v_cvt_pk_bf16_f32 v91, v150, v151
    ds_write_b128 v8, v[88:91] offset:8192
    v_mul_f32 v144, v153, v154
    v_add_f32 v146, v144, v155
    v_add_f32 v148, v146, v155
    v_add_f32 v150, v148, v155
    v_fract_f32 v144, v144
    v_fract_f32 v146, v146
    v_fract_f32 v148, v148
    v_fract_f32 v150, v150
    v_sin_f32 v145, v144
    v_cos_f32 v144, v144
    v_sin_f32 v147, v146
    v_cos_f32 v146, v146
    v_sin_f32 v149, v148
    v_cos_f32 v148, v148
    v_sin_f32 v151, v150
    v_cos_f32 v150, v150
    v_mul_f32 v145, s34, v145
    v_mul_f32 v144, s33, v144
    v_mul_f32 v147, s34, v147
    v_mul_f32 v146, s33, v146
    v_mul_f32 v149, s34, v149
    v_mul_f32 v148, s33, v148
    v_mul_f32 v151, s34, v151
    v_mul_f32 v150, s33, v150
    v_cvt_pk_bf16_f32 v92, v144, v145
    v_cvt_pk_bf16_f32 v93, v146, v147
    v_cvt_pk_bf16_f32 v94, v148, v149
    v_cvt_pk_bf16_f32 v95, v150, v151
    ds_write_b128 v8, v[92:95] offset:9216
    v_add_f32 v154, 0x3e000000, v154
    v_mul_f32 v155, 4.0, v154
    v_mul_f32 v144, v152, v154
    v_add_f32 v146, v144, v155
    v_add_f32 v148, v146, v155
    v_add_f32 v150, v148, v155
    v_fract_f32 v144, v144
    v_fract_f32 v146, v146
    v_fract_f32 v148, v148
    v_fract_f32 v150, v150
    v_sin_f32 v145, v144
    v_cos_f32 v144, v144
    v_sin_f32 v147, v146
    v_cos_f32 v146, v146
    v_sin_f32 v149, v148
    v_cos_f32 v148, v148
    v_sin_f32 v151, v150
    v_cos_f32 v150, v150
    v_mul_f32 v145, s34, v145
    v_mul_f32 v144, s33, v144
    v_mul_f32 v147, s34, v147
    v_mul_f32 v146, s33, v146
    v_mul_f32 v149, s34, v149
    v_mul_f32 v148, s33, v148
    v_mul_f32 v151, s34, v151
    v_mul_f32 v150, s33, v150
    v_cvt_pk_bf16_f32 v96, v144, v145
    v_cvt_pk_bf16_f32 v97, v146, v147
    v_cvt_pk_bf16_f32 v98, v148, v149
    v_cvt_pk_bf16_f32 v99, v150, v151
    ds_write_b128 v8, v[96:99] offset:16384
    v_mul_f32 v144, v153, v154
    v_add_f32 v146, v144, v155
    v_add_f32 v148, v146, v155
    v_add_f32 v150, v148, v155
    v_fract_f32 v144, v144
    v_fract_f32 v146, v146
    v_fract_f32 v148, v148
    v_fract_f32 v150, v150
    v_sin_f32 v145, v144
    v_cos_f32 v144, v144
    v_sin_f32 v147, v146
    v_cos_f32 v146, v146
    v_sin_f32 v149, v148
    v_cos_f32 v148, v148
    v_sin_f32 v151, v150
    v_cos_f32 v150, v150
    v_mul_f32 v145, s34, v145
    v_mul_f32 v144, s33, v144
    v_mul_f32 v147, s34, v147
    v_mul_f32 v146, s33, v146
    v_mul_f32 v149, s34, v149
    v_mul_f32 v148, s33, v148
    v_mul_f32 v151, s34, v151
    v_mul_f32 v150, s33, v150
    v_cvt_pk_bf16_f32 v100, v144, v145
    v_cvt_pk_bf16_f32 v101, v146, v147
    v_cvt_pk_bf16_f32 v102, v148, v149
    v_cvt_pk_bf16_f32 v103, v150, v151
    ds_write_b128 v8, v[100:103] offset:17408
    s_cmp_eq_u32 s63, 0
    s_cbranch_scc1 L_nox3
    s_waitcnt vmcnt(18) lgkmcnt(0)
    s_branch L_witems
L_nox3:
    s_waitcnt vmcnt(0) lgkmcnt(0)
L_witems:
    s_barrier
    s_cmp_eq_u32 s29, 0
    s_cbranch_scc1 L_wdone
L_witem:
    ds_read_b64_tr_b16 v[48:49], v4 offset:0
    ds_read_b64_tr_b16 v[50:51], v4 offset:1024
    ds_read_b64_tr_b16 v[52:53], v4 offset:4096
    ds_read_b64_tr_b16 v[54:55], v4 offset:5120
    ds_read_b64_tr_b16 v[56:57], v4 offset:256
    ds_read_b64_tr_b16 v[58:59], v4 offset:1280
    ds_read_b64_tr_b16 v[60:61], v4 offset:4352
    ds_read_b64_tr_b16 v[62:63], v4 offset:5376
    ds_read_b64_tr_b16 v[64:65], v4 offset:512
    ds_read_b64_tr_b16 v[66:67], v4 offset:1536
    ds_read_b64_tr_b16 v[68:69], v4 offset:4608
    ds_read_b64_tr_b16 v[70:71], v4 offset:5632
    s_waitcnt lgkmcnt(8)
    ds_read_b64_tr_b16 v[72:73], v4 offset:768
    ds_read_b64_tr_b16 v[74:75], v4 offset:1792
    ds_read_b64_tr_b16 v[76:77], v4 offset:4864
    ds_read_b64_tr_b16 v[78:79], v4 offset:5888
    s_mul_i32 s33, s28, 7282
    s_lshr_b32 s33, s33, 16
    s_mul_i32 s34, s33, 9
    s_sub_u32 s34, s28, s34
    s_lshl_b32 s34, s34, 1
    v_add_u32 v8, s34, v11
    v_cmp_le_u32 vcc, 9, v8
    v_subrev_u32 v12, 9, v8
    s_lshr_b32 s34, s33, 2
    v_cndmask_b32 v8, v8, v12, vcc
    v_cndmask_b32 v10, 0, 1, vcc
    s_lshl_b32 s35, s34, 1
    v_lshrrev_b32 v12, 2, v8
    v_add_u32 v12, s35, v12
    v_and_b32 v13, 3, v8
    v_lshl_add_u32 v13, v13, 1, v10
    v_cmp_eq_u32 vcc, 8, v8
    s_lshr_b32 s35, s34, 2
    s_add_u32 s35, s35, 18
    v_mov_b32 v8, s35
    s_and_b32 s35, s34, 3
    v_lshl_add_u32 v10, v10, 2, s35
    v_cndmask_b32 v12, v12, v8, vcc
    v_cndmask_b32 v13, v13, v10, vcc
    v_lshlrev_b32 v8, 11, v12
    v_and_b32 v8, 8192, v8
    v_xor_b32 v8, v5, v8
    v_lshl_add_u32 v8, v12, 19, v8
    v_lshl_add_u32 v8, v13, 10, v8
    s_and_b32 s33, s33, 3
    s_lshl_b32 s33, s33, 8
    v_add_u32 v12, s33, v8
    s_waitcnt lgkmcnt(12)
    v_mfma_f32_32x32x16_bf16 v[80:95], v[16:19], v[48:51], 0
    v_mfma_f32_32x32x16_bf16 v[80:95], v[20:23], v[52:55], v[80:95]
    s_waitcnt lgkmcnt(8)
    v_mfma_f32_32x32x16_bf16 v[96:111], v[16:19], v[56:59], 0
    v_mfma_f32_32x32x16_bf16 v[96:111], v[20:23], v[60:63], v[96:111]
    s_nop 8
    v_cvt_pk_bf16_f32 v112, v80, v81
    v_cvt_pk_bf16_f32 v116, v82, v83
    v_cvt_pk_bf16_f32 v120, v84, v85
    v_cvt_pk_bf16_f32 v124, v86, v87
    v_cvt_pk_bf16_f32 v128, v88, v89
    v_cvt_pk_bf16_f32 v132, v90, v91
    v_cvt_pk_bf16_f32 v136, v92, v93
    v_cvt_pk_bf16_f32 v140, v94, v95
    s_waitcnt lgkmcnt(4)
    v_mfma_f32_32x32x16_bf16 v[80:95], v[16:19], v[64:67], 0
    v_mfma_f32_32x32x16_bf16 v[80:95], v[20:23], v[68:71], v[80:95]
    v_cvt_pk_bf16_f32 v113, v96, v97
    v_cvt_pk_bf16_f32 v117, v98, v99
    v_cvt_pk_bf16_f32 v121, v100, v101
    v_cvt_pk_bf16_f32 v125, v102, v103
    v_cvt_pk_bf16_f32 v129, v104, v105
    v_cvt_pk_bf16_f32 v133, v106, v107
    v_cvt_pk_bf16_f32 v137, v108, v109
    v_cvt_pk_bf16_f32 v141, v110, v111
    s_waitcnt lgkmcnt(0)
    v_mfma_f32_32x32x16_bf16 v[96:111], v[16:19], v[72:75], 0
    v_mfma_f32_32x32x16_bf16 v[96:111], v[20:23], v[76:79], v[96:111]
    s_nop 0
    v_cvt_pk_bf16_f32 v114, v80, v81
    v_cvt_pk_bf16_f32 v118, v82, v83
    v_cvt_pk_bf16_f32 v122, v84, v85
    v_cvt_pk_bf16_f32 v126, v86, v87
    v_cvt_pk_bf16_f32 v130, v88, v89
    v_cvt_pk_bf16_f32 v134, v90, v91
    v_cvt_pk_bf16_f32 v138, v92, v93
    v_cvt_pk_bf16_f32 v142, v94, v95
    s_nop 2
    v_cvt_pk_bf16_f32 v115, v96, v97
    v_cvt_pk_bf16_f32 v119, v98, v99
    v_cvt_pk_bf16_f32 v123, v100, v101
    v_cvt_pk_bf16_f32 v127, v102, v103
    v_cvt_pk_bf16_f32 v131, v104, v105
    v_cvt_pk_bf16_f32 v135, v106, v107
    v_cvt_pk_bf16_f32 v139, v108, v109
    v_cvt_pk_bf16_f32 v143, v110, v111
    s_cmp_eq_u32 s63, 1
    s_cbranch_scc1 L_wdone
    buffer_store_dwordx4 v[112:115], v12, s[12:15], 0 offen sc1
    buffer_store_dwordx4 v[116:119], v12, s[12:15], s41 offen sc1
    buffer_store_dwordx4 v[120:123], v12, s[12:15], s42 offen sc1
    buffer_store_dwordx4 v[124:127], v12, s[12:15], s43 offen sc1
    buffer_store_dwordx4 v[128:131], v12, s[12:15], s44 offen sc1
    buffer_store_dwordx4 v[132:135], v12, s[12:15], s45 offen sc1
    buffer_store_dwordx4 v[136:139], v12, s[12:15], s46 offen sc1
    buffer_store_dwordx4 v[140:143], v12, s[12:15], s47 offen sc1
    v_add_u32 v4, 8192, v4
    s_add_u32 s28, s28, 1
    s_cmp_lt_u32 s28, s32
    s_cbranch_scc1 L_witem
L_wdone:
    ds_read_b128 a[180:183], v15 offset:0
    ds_read_b128 a[184:187], v15 offset:1024
    ds_read_b128 a[188:191], v15 offset:2048
    ds_read_b128 a[192:195], v15 offset:3072
    ds_read_b128 a[196:199], v15 offset:4096
    ds_read_b128 a[200:203], v15 offset:5120
    ds_read_b128 a[204:207], v15 offset:6144
    ds_read_b128 a[208:211], v15 offset:7168
    ds_read_b128 a[212:215], v15 offset:8192
    ds_read_b128 a[216:219], v15 offset:9216
    ds_read_b128 a[220:223], v15 offset:10240
    ds_read_b128 a[224:227], v15 offset:11264
    s_waitcnt lgkmcnt(2)
    ds_read_b128 a[228:231], v15 offset:12288
    ds_read_b128 a[232:235], v15 offset:13312
    ds_read_b128 a[236:239], v15 offset:14336
    ds_read_b128 a[240:243], v15 offset:15360
    ds_read_b128 a[244:247], v15 offset:16384
    ds_read_b128 a[248:251], v15 offset:17408
    ds_read_b128 a[252:255], v15 offset:18432
    ds_read_b128 v[236:239], v15 offset:19456
    ds_read_b128 v[240:243], v15 offset:20480
    ds_read_b128 v[244:247], v15 offset:21504
    ds_read_b128 v[248:251], v15 offset:22528
    ds_read_b128 v[252:255], v15 offset:23552
    s_waitcnt lgkmcnt(8)
    s_cmp_eq_u32 s63, 0
    s_cbranch_scc1 L_p1done
L_xgo:
    v_bfe_u32 v8, v1, 2, 1
    v_mul_u32_u24 v5, 1152, v8
    v_bfe_u32 v8, v1, 3, 1
    v_mul_u32_u24 v8, 18496, v8
    v_mul_u32_u24 v4, 4608, v9
    v_add3_u32 v5, v5, v8, v4
    v_bfe_u32 v8, v1, 1, 1
    v_mul_u32_u24 v8, 288, v8
    v_add_u32 v5, v5, v8
    v_bfe_u32 v8, v1, 4, 1
    v_lshl_add_u32 v5, v8, 4, v5
    v_and_b32 v8, 1, v1
    v_lshl_add_u32 v5, v8, 3, v5
    s_lshr_b32 s30, s20, 1
    s_lshl_b32 s3, s30, 7
    v_add_u32 v4, s3, v5
    s_mul_i32 s35, s23, 9363
    s_lshr_b32 s35, s35, 16
    s_mul_i32 s33, s35, 7
    s_sub_u32 s33, s23, s33
    s_and_b32 s34, s33, 4
    s_bfe_u32 s3, s33, 0x10001
    s_or_b32 s34, s34, s3
    s_lshl_b32 s34, s34, 4
    s_mul_i32 s33, s33, 1152
    s_lshl_b32 s3, s30, 9
    s_add_u32 s33, s33, s3
    s_lshl_b32 s3, s35, 19
    s_add_u32 s33, s33, s3
    s_lshl_b32 s3, s35, 11
    s_and_b32 s3, s3, 8192
    s_add_u32 s33, s33, s3
    s_add_u32 s33, s33, 4194304
    v_and_b32 v3, 31, v1
    v_lshlrev_b32 v3, 2, v3
    v_xor_b32 v3, s34, v3
    v_add_u32 v3, s33, v3
    s_and_b32 s3, s20, 1
    s_lshl_b32 s3, s3, 3
    v_add_u32 v8, s3, v9
    v_lshlrev_b32 v8, 15, v8
    v_xor_b32 v11, 8192, v3
    v_sub_u32 v11, v11, v8
    v_add_u32 v11, 294912, v11
    v_add_u32 v3, v3, v8
    s_cmp_eq_u32 s30, 0
    s_cselect_b64 vcc, -1, 0
    v_add_u32 v12, 1024, v3
    v_add_u32 v8, 512, v11
    v_cndmask_b32 v12, v8, v12, vcc
    s_cselect_b32 s31, 1.0, -1.0
    s_mov_b32 s48, 16384
    s_mov_b32 s49, 65536
    s_mov_b32 s50, 81920
    s_mov_b32 s51, 131072
    s_mov_b32 s64, 147456
    s_mov_b32 s65, 196608
    s_mov_b32 s66, 212992
    s_cselect_b32 s40, 0, s66
    s_cselect_b32 s41, s48, s65
    s_cselect_b32 s42, s49, s64
    s_cselect_b32 s43, s50, s51
    s_cselect_b32 s44, s51, s50
    s_cselect_b32 s45, s64, s49
    s_cselect_b32 s46, s65, s48
    s_cselect_b32 s47, s66, 0
    s_waitcnt vmcnt(0) lgkmcnt(0)
    s_barrier
    ds_read_b64_tr_b16 v[48:49], v4 offset:0
    ds_read_b64_tr_b16 v[50:51], v4 offset:2304
    ds_read_b64_tr_b16 v[52:53], v4 offset:9216
    ds_read_b64_tr_b16 v[54:55], v4 offset:11520
    ds_read_b64_tr_b16 v[56:57], v4 offset:36992
    ds_read_b64_tr_b16 v[58:59], v4 offset:39296
    ds_read_b64_tr_b16 v[60:61], v4 offset:46208
    ds_read_b64_tr_b16 v[62:63], v4 offset:48512
    s_waitcnt lgkmcnt(6)
    v_mfma_f32_32x32x16_bf16 v[80:95], v[16:19], v[48:51], 0
    ds_read_b64_tr_b16 v[64:65], v4 offset:576
    ds_read_b64_tr_b16 v[66:67], v4 offset:2880
    s_waitcnt lgkmcnt(6)
    v_mfma_f32_32x32x16_bf16 v[80:95], v[20:23], v[52:55], v[80:95]
    ds_read_b64_tr_b16 v[68:69], v4 offset:9792
    ds_read_b64_tr_b16 v[70:71], v4 offset:12096
    s_waitcnt lgkmcnt(6)
    v_mfma_f32_32x32x16_bf16 v[80:95], v[24:27], v[56:59], v[80:95]
    ds_read_b64_tr_b16 v[72:73], v4 offset:37568
    ds_read_b64_tr_b16 v[74:75], v4 offset:39872
    s_waitcnt lgkmcnt(6)
    v_mfma_f32_32x32x16_bf16 v[80:95], v[28:31], v[60:63], v[80:95]
    ds_read_b64_tr_b16 v[76:77], v4 offset:46784
    ds_read_b64_tr_b16 v[78:79], v4 offset:49088
    s_waitcnt lgkmcnt(6)
    v_mfma_f32_32x32x16_bf16 v[96:111], v[32:35], v[64:67], 0
    ds_read_b64_tr_b16 v[48:49], v4 offset:32
    ds_read_b64_tr_b16 v[50:51], v4 offset:2336
    s_waitcnt lgkmcnt(6)
    v_mfma_f32_32x32x16_bf16 v[96:111], v[36:39], v[68:71], v[96:111]
    ds_read_b64_tr_b16 v[52:53], v4 offset:9248
    ds_read_b64_tr_b16 v[54:55], v4 offset:11552
    s_waitcnt lgkmcnt(6)
    v_mfma_f32_32x32x16_bf16 v[96:111], v[40:43], v[72:75], v[96:111]
    ds_read_b64_tr_b16 v[56:57], v4 offset:37024
    ds_read_b64_tr_b16 v[58:59], v4 offset:39328
    s_waitcnt lgkmcnt(6)
    v_mfma_f32_32x32x16_bf16 v[96:111], v[44:47], v[76:79], v[96:111]
    ds_read_b64_tr_b16 v[60:61], v4 offset:46240
    ds_read_b64_tr_b16 v[62:63], v4 offset:48544
    s_waitcnt lgkmcnt(6)
    v_mfma_f32_32x32x16_bf16 v[112:127], v[16:19], v[48:51], 0
    ds_read_b64_tr_b16 v[64:65], v4 offset:608
    ds_read_b64_tr_b16 v[66:67], v4 offset:2912
    s_waitcnt lgkmcnt(6)
    v_mfma_f32_32x32x16_bf16 v[112:127], v[20:23], v[52:55], v[112:127]
    ds_read_b64_tr_b16 v[68:69], v4 offset:9824
    ds_read_b64_tr_b16 v[70:71], v4 offset:12128
    s_waitcnt lgkmcnt(6)
    v_mfma_f32_32x32x16_bf16 v[112:127], v[24:27], v[56:59], v[112:127]
    ds_read_b64_tr_b16 v[72:73], v4 offset:37600
    ds_read_b64_tr_b16 v[74:75], v4 offset:39904
    v_add_f32 v144, v80, v96
    v_add_f32 v145, v81, v97
    v_sub_f32 v96, v80, v96
    v_sub_f32 v97, v97, v81
    v_cvt_pk_bf16_f32 v80, v144, v145
    buffer_store_dword v80, v3, s[12:15], 0 offen offset:0 sc1
    v_cvt_pk_bf16_f32 v96, v96, v97
    buffer_store_dword v96, v11, s[12:15], s66 offen offset:0 sc1
    v_add_f32 v146, v82, v98
    v_add_f32 v147, v83, v99
    v_sub_f32 v98, v82, v98
    v_sub_f32 v99, v99, v83
    v_cvt_pk_bf16_f32 v82, v146, v147
    buffer_store_dword v82, v3, s[12:15], s48 offen offset:0 sc1
    s_waitcnt lgkmcnt(6)
    v_mfma_f32_32x32x16_bf16 v[112:127], v[28:31], v[60:63], v[112:127]
    ds_read_b64_tr_b16 v[76:77], v4 offset:46816
    ds_read_b64_tr_b16 v[78:79], v4 offset:49120
    v_cvt_pk_bf16_f32 v98, v98, v99
    buffer_store_dword v98, v11, s[12:15], s65 offen offset:0 sc1
    v_add_f32 v148, v84, v100
    v_add_f32 v149, v85, v101
    v_sub_f32 v100, v84, v100
    v_sub_f32 v101, v101, v85
    v_cvt_pk_bf16_f32 v84, v148, v149
    buffer_store_dword v84, v3, s[12:15], s49 offen offset:0 sc1
    v_cvt_pk_bf16_f32 v100, v100, v101
    buffer_store_dword v100, v11, s[12:15], s64 offen offset:0 sc1
    s_waitcnt lgkmcnt(6)
    v_mfma_f32_32x32x16_bf16 v[128:143], v[32:35], v[64:67], 0
    ds_read_b64_tr_b16 v[48:49], v4 offset:64
    ds_read_b64_tr_b16 v[50:51], v4 offset:2368
    v_add_f32 v150, v86, v102
    v_add_f32 v151, v87, v103
    v_sub_f32 v102, v86, v102
    v_sub_f32 v103, v103, v87
    v_cvt_pk_bf16_f32 v86, v150, v151
    buffer_store_dword v86, v3, s[12:15], s50 offen offset:0 sc1
    v_cvt_pk_bf16_f32 v102, v102, v103
    buffer_store_dword v102, v11, s[12:15], s51 offen offset:0 sc1
    v_add_f32 v144, v88, v104
    v_add_f32 v145, v89, v105
    v_sub_f32 v104, v88, v104
    v_sub_f32 v105, v105, v89
    v_cvt_pk_bf16_f32 v88, v144, v145
    buffer_store_dword v88, v3, s[12:15], s51 offen offset:0 sc1
    s_waitcnt lgkmcnt(6)
    v_mfma_f32_32x32x16_bf16 v[128:143], v[36:39], v[68:71], v[128:143]
    ds_read_b64_tr_b16 v[52:53], v4 offset:9280
    ds_read_b64_tr_b16 v[54:55], v4 offset:11584
    v_cvt_pk_bf16_f32 v104, v104, v105
    buffer_store_dword v104, v11, s[12:15], s50 offen offset:0 sc1
    v_add_f32 v146, v90, v106
    v_add_f32 v147, v91, v107
    v_sub_f32 v106, v90, v106
    v_sub_f32 v107, v107, v91
    v_cvt_pk_bf16_f32 v90, v146, v147
    buffer_store_dword v90, v3, s[12:15], s64 offen offset:0 sc1
    v_cvt_pk_bf16_f32 v106, v106, v107
    buffer_store_dword v106, v11, s[12:15], s49 offen offset:0 sc1
    s_waitcnt lgkmcnt(6)
    v_mfma_f32_32x32x16_bf16 v[128:143], v[40:43], v[72:75], v[128:143]
    ds_read_b64_tr_b16 v[56:57], v4 offset:37056
    ds_read_b64_tr_b16 v[58:59], v4 offset:39360
    v_add_f32 v148, v92, v108
    v_add_f32 v149, v93, v109
    v_sub_f32 v108, v92, v108
    v_sub_f32 v109, v109, v93
    v_cvt_pk_bf16_f32 v92, v148, v149
    buffer_store_dword v92, v3, s[12:15], s65 offen offset:0 sc1
    v_cvt_pk_bf16_f32 v108, v108, v109
    buffer_store_dword v108, v11, s[12:15], s48 offen offset:0 sc1
    v_add_f32 v150, v94, v110
    v_add_f32 v151, v95, v111
    v_sub_f32 v110, v94, v110
    v_sub_f32 v111, v111, v95
    v_cvt_pk_bf16_f32 v94, v150, v151
    buffer_store_dword v94, v3, s[12:15], s66 offen offset:0 sc1
    s_waitcnt lgkmcnt(6)
    v_mfma_f32_32x32x16_bf16 v[128:143], v[44:47], v[76:79], v[128:143]
    ds_read_b64_tr_b16 v[60:61], v4 offset:46272
    ds_read_b64_tr_b16 v[62:63], v4 offset:48576
    v_cvt_pk_bf16_f32 v110, v110, v111
    buffer_store_dword v110, v11, s[12:15], 0 offen offset:0 sc1
    s_waitcnt lgkmcnt(6)
    v_mfma_f32_32x32x16_bf16 v[80:95], v[16:19], v[48:51], 0
    ds_read_b64_tr_b16 v[64:65], v4 offset:640
    ds_read_b64_tr_b16 v[66:67], v4 offset:2944
    s_waitcnt lgkmcnt(6)
    v_mfma_f32_32x32x16_bf16 v[80:95], v[20:23], v[52:55], v[80:95]
    ds_read_b64_tr_b16 v[68:69], v4 offset:9856
    ds_read_b64_tr_b16 v[70:71], v4 offset:12160
    s_waitcnt lgkmcnt(6)
    v_mfma_f32_32x32x16_bf16 v[80:95], v[24:27], v[56:59], v[80:95]
    ds_read_b64_tr_b16 v[72:73], v4 offset:37632
    ds_read_b64_tr_b16 v[74:75], v4 offset:39936
    v_add_f32 v144, v112, v128
    v_add_f32 v145, v113, v129
    v_sub_f32 v128, v112, v128
    v_sub_f32 v129, v129, v113
    v_cvt_pk_bf16_f32 v112, v144, v145
    buffer_store_dword v112, v3, s[12:15], 0 offen offset:128 sc1
    v_cvt_pk_bf16_f32 v128, v128, v129
    buffer_store_dword v128, v11, s[12:15], s66 offen offset:128 sc1
    v_add_f32 v146, v114, v130
    v_add_f32 v147, v115, v131
    v_sub_f32 v130, v114, v130
    v_sub_f32 v131, v131, v115
    v_cvt_pk_bf16_f32 v114, v146, v147
    buffer_store_dword v114, v3, s[12:15], s48 offen offset:128 sc1
    s_waitcnt lgkmcnt(6)
    v_mfma_f32_32x32x16_bf16 v[80:95], v[28:31], v[60:63], v[80:95]
    ds_read_b64_tr_b16 v[76:77], v4 offset:46848
    ds_read_b64_tr_b16 v[78:79], v4 offset:49152
    v_cvt_pk_bf16_f32 v130, v130, v131
    buffer_store_dword v130, v11, s[12:15], s65 offen offset:128 sc1
    v_add_f32 v148, v116, v132
    v_add_f32 v149, v117, v133
    v_sub_f32 v132, v116, v132
    v_sub_f32 v133, v133, v117
    v_cvt_pk_bf16_f32 v116, v148, v149
    buffer_store_dword v116, v3, s[12:15], s49 offen offset:128 sc1
    v_cvt_pk_bf16_f32 v132, v132, v133
    buffer_store_dword v132, v11, s[12:15], s64 offen offset:128 sc1
    s_waitcnt lgkmcnt(6)
    v_mfma_f32_32x32x16_bf16 v[96:111], v[32:35], v[64:67], 0
    ds_read_b64_tr_b16 v[48:49], v4 offset:96
    ds_read_b64_tr_b16 v[50:51], v4 offset:2400
    v_add_f32 v150, v118, v134
    v_add_f32 v151, v119, v135
    v_sub_f32 v134, v118, v134
    v_sub_f32 v135, v135, v119
    v_cvt_pk_bf16_f32 v118, v150, v151
    buffer_store_dword v118, v3, s[12:15], s50 offen offset:128 sc1
    v_cvt_pk_bf16_f32 v134, v134, v135
    buffer_store_dword v134, v11, s[12:15], s51 offen offset:128 sc1
    v_add_f32 v144, v120, v136
    v_add_f32 v145, v121, v137
    v_sub_f32 v136, v120, v136
    v_sub_f32 v137, v137, v121
    v_cvt_pk_bf16_f32 v120, v144, v145
    buffer_store_dword v120, v3, s[12:15], s51 offen offset:128 sc1
    s_waitcnt lgkmcnt(6)
    v_mfma_f32_32x32x16_bf16 v[96:111], v[36:39], v[68:71], v[96:111]
    ds_read_b64_tr_b16 v[52:53], v4 offset:9312
    ds_read_b64_tr_b16 v[54:55], v4 offset:11616
    v_cvt_pk_bf16_f32 v136, v136, v137
    buffer_store_dword v136, v11, s[12:15], s50 offen offset:128 sc1
    v_add_f32 v146, v122, v138
    v_add_f32 v147, v123, v139
    v_sub_f32 v138, v122, v138
    v_sub_f32 v139, v139, v123
    v_cvt_pk_bf16_f32 v122, v146, v147
    buffer_store_dword v122, v3, s[12:15], s64 offen offset:128 sc1
    v_cvt_pk_bf16_f32 v138, v138, v139
    buffer_store_dword v138, v11, s[12:15], s49 offen offset:128 sc1
    s_waitcnt lgkmcnt(6)
    v_mfma_f32_32x32x16_bf16 v[96:111], v[40:43], v[72:75], v[96:111]
    ds_read_b64_tr_b16 v[56:57], v4 offset:37088
    ds_read_b64_tr_b16 v[58:59], v4 offset:39392
    v_add_f32 v148, v124, v140
    v_add_f32 v149, v125, v141
    v_sub_f32 v140, v124, v140
    v_sub_f32 v141, v141, v125
    v_cvt_pk_bf16_f32 v124, v148, v149
    buffer_store_dword v124, v3, s[12:15], s65 offen offset:128 sc1
    v_cvt_pk_bf16_f32 v140, v140, v141
    buffer_store_dword v140, v11, s[12:15], s48 offen offset:128 sc1
    v_add_f32 v150, v126, v142
    v_add_f32 v151, v127, v143
    v_sub_f32 v142, v126, v142
    v_sub_f32 v143, v143, v127
    v_cvt_pk_bf16_f32 v126, v150, v151
    buffer_store_dword v126, v3, s[12:15], s66 offen offset:128 sc1
    s_waitcnt lgkmcnt(6)
    v_mfma_f32_32x32x16_bf16 v[96:111], v[44:47], v[76:79], v[96:111]
    ds_read_b64_tr_b16 v[60:61], v4 offset:46304
    ds_read_b64_tr_b16 v[62:63], v4 offset:48608
    v_cvt_pk_bf16_f32 v142, v142, v143
    buffer_store_dword v142, v11, s[12:15], 0 offen offset:128 sc1
    s_waitcnt lgkmcnt(6)
    v_mfma_f32_32x32x16_bf16 v[112:127], v[16:19], v[48:51], 0
    ds_read_b64_tr_b16 v[64:65], v4 offset:672
    ds_read_b64_tr_b16 v[66:67], v4 offset:2976
    s_waitcnt lgkmcnt(6)
    v_mfma_f32_32x32x16_bf16 v[112:127], v[20:23], v[52:55], v[112:127]
    ds_read_b64_tr_b16 v[68:69], v4 offset:9888
    ds_read_b64_tr_b16 v[70:71], v4 offset:12192
    s_waitcnt lgkmcnt(6)
    v_mfma_f32_32x32x16_bf16 v[112:127], v[24:27], v[56:59], v[112:127]
    ds_read_b64_tr_b16 v[72:73], v4 offset:37664
    ds_read_b64_tr_b16 v[74:75], v4 offset:39968
    v_add_f32 v144, v80, v96
    v_add_f32 v145, v81, v97
    v_sub_f32 v96, v80, v96
    v_sub_f32 v97, v97, v81
    v_cvt_pk_bf16_f32 v80, v144, v145
    buffer_store_dword v80, v3, s[12:15], 0 offen offset:256 sc1
    v_cvt_pk_bf16_f32 v96, v96, v97
    buffer_store_dword v96, v11, s[12:15], s66 offen offset:256 sc1
    v_add_f32 v146, v82, v98
    v_add_f32 v147, v83, v99
    v_sub_f32 v98, v82, v98
    v_sub_f32 v99, v99, v83
    v_cvt_pk_bf16_f32 v82, v146, v147
    buffer_store_dword v82, v3, s[12:15], s48 offen offset:256 sc1
    s_waitcnt lgkmcnt(6)
    v_mfma_f32_32x32x16_bf16 v[112:127], v[28:31], v[60:63], v[112:127]
    ds_read_b64_tr_b16 v[76:77], v4 offset:46880
    ds_read_b64_tr_b16 v[78:79], v4 offset:49184
    v_cvt_pk_bf16_f32 v98, v98, v99
    buffer_store_dword v98, v11, s[12:15], s65 offen offset:256 sc1
    v_add_f32 v148, v84, v100
    v_add_f32 v149, v85, v101
    v_sub_f32 v100, v84, v100
    v_sub_f32 v101, v101, v85
    v_cvt_pk_bf16_f32 v84, v148, v149
    buffer_store_dword v84, v3, s[12:15], s49 offen offset:256 sc1
    v_cvt_pk_bf16_f32 v100, v100, v101
    buffer_store_dword v100, v11, s[12:15], s64 offen offset:256 sc1
    s_waitcnt lgkmcnt(6)
    v_mfma_f32_32x32x16_bf16 v[128:143], v[32:35], v[64:67], 0
    ds_read_b64_tr_b16 v[48:49], v5 offset:256
    ds_read_b64_tr_b16 v[50:51], v5 offset:2560
    v_add_f32 v150, v86, v102
    v_add_f32 v151, v87, v103
    v_sub_f32 v102, v86, v102
    v_sub_f32 v103, v103, v87
    v_cvt_pk_bf16_f32 v86, v150, v151
    buffer_store_dword v86, v3, s[12:15], s50 offen offset:256 sc1
    v_cvt_pk_bf16_f32 v102, v102, v103
    buffer_store_dword v102, v11, s[12:15], s51 offen offset:256 sc1
    v_add_f32 v144, v88, v104
    v_add_f32 v145, v89, v105
    v_sub_f32 v104, v88, v104
    v_sub_f32 v105, v105, v89
    v_cvt_pk_bf16_f32 v88, v144, v145
    buffer_store_dword v88, v3, s[12:15], s51 offen offset:256 sc1
    s_waitcnt lgkmcnt(6)
    v_mfma_f32_32x32x16_bf16 v[128:143], v[36:39], v[68:71], v[128:143]
    ds_read_b64_tr_b16 v[52:53], v5 offset:9472
    ds_read_b64_tr_b16 v[54:55], v5 offset:11776
    v_cvt_pk_bf16_f32 v104, v104, v105
    buffer_store_dword v104, v11, s[12:15], s50 offen offset:256 sc1
    v_add_f32 v146, v90, v106
    v_add_f32 v147, v91, v107
    v_sub_f32 v106, v90, v106
    v_sub_f32 v107, v107, v91
    v_cvt_pk_bf16_f32 v90, v146, v147
    buffer_store_dword v90, v3, s[12:15], s64 offen offset:256 sc1
    v_cvt_pk_bf16_f32 v106, v106, v107
    buffer_store_dword v106, v11, s[12:15], s49 offen offset:256 sc1
    s_waitcnt lgkmcnt(6)
    v_mfma_f32_32x32x16_bf16 v[128:143], v[40:43], v[72:75], v[128:143]
    ds_read_b64_tr_b16 v[56:57], v5 offset:37248
    ds_read_b64_tr_b16 v[58:59], v5 offset:39552
    v_add_f32 v148, v92, v108
    v_add_f32 v149, v93, v109
    v_sub_f32 v108, v92, v108
    v_sub_f32 v109, v109, v93
    v_cvt_pk_bf16_f32 v92, v148, v149
    buffer_store_dword v92, v3, s[12:15], s65 offen offset:256 sc1
    v_cvt_pk_bf16_f32 v108, v108, v109
    buffer_store_dword v108, v11, s[12:15], s48 offen offset:256 sc1
    v_add_f32 v150, v94, v110
    v_add_f32 v151, v95, v111
    v_sub_f32 v110, v94, v110
    v_sub_f32 v111, v111, v95
    v_cvt_pk_bf16_f32 v94, v150, v151
    buffer_store_dword v94, v3, s[12:15], s66 offen offset:256 sc1
    s_waitcnt lgkmcnt(6)
    v_mfma_f32_32x32x16_bf16 v[128:143], v[44:47], v[76:79], v[128:143]
    ds_read_b64_tr_b16 v[60:61], v5 offset:46464
    ds_read_b64_tr_b16 v[62:63], v5 offset:48768
    v_cvt_pk_bf16_f32 v110, v110, v111
    buffer_store_dword v110, v11, s[12:15], 0 offen offset:256 sc1
    s_waitcnt lgkmcnt(6)
    v_mfma_f32_32x32x16_bf16 v[80:95], v[16:19], v[48:51], 0
    ds_read_b64_tr_b16 v[64:65], v5 offset:832
    ds_read_b64_tr_b16 v[66:67], v5 offset:3136
    s_waitcnt lgkmcnt(6)
    v_mfma_f32_32x32x16_bf16 v[80:95], v[20:23], v[52:55], v[80:95]
    ds_read_b64_tr_b16 v[68:69], v5 offset:10048
    ds_read_b64_tr_b16 v[70:71], v5 offset:12352
    s_waitcnt lgkmcnt(6)
    v_mfma_f32_32x32x16_bf16 v[80:95], v[24:27], v[56:59], v[80:95]
    ds_read_b64_tr_b16 v[72:73], v5 offset:37824
    ds_read_b64_tr_b16 v[74:75], v5 offset:40128
    v_add_f32 v144, v112, v128
    v_add_f32 v145, v113, v129
    v_sub_f32 v128, v112, v128
    v_sub_f32 v129, v129, v113
    v_cvt_pk_bf16_f32 v112, v144, v145
    buffer_store_dword v112, v3, s[12:15], 0 offen offset:384 sc1
    v_cvt_pk_bf16_f32 v128, v128, v129
    buffer_store_dword v128, v11, s[12:15], s66 offen offset:384 sc1
    v_add_f32 v146, v114, v130
    v_add_f32 v147, v115, v131
    v_sub_f32 v130, v114, v130
    v_sub_f32 v131, v131, v115
    v_cvt_pk_bf16_f32 v114, v146, v147
    buffer_store_dword v114, v3, s[12:15], s48 offen offset:384 sc1
    s_waitcnt lgkmcnt(6)
    v_mfma_f32_32x32x16_bf16 v[80:95], v[28:31], v[60:63], v[80:95]
    ds_read_b64_tr_b16 v[76:77], v5 offset:47040
    ds_read_b64_tr_b16 v[78:79], v5 offset:49344
    v_cvt_pk_bf16_f32 v130, v130, v131
    buffer_store_dword v130, v11, s[12:15], s65 offen offset:384 sc1
    v_add_f32 v148, v116, v132
    v_add_f32 v149, v117, v133
    v_sub_f32 v132, v116, v132
    v_sub_f32 v133, v133, v117
    v_cvt_pk_bf16_f32 v116, v148, v149
    buffer_store_dword v116, v3, s[12:15], s49 offen offset:384 sc1
    v_cvt_pk_bf16_f32 v132, v132, v133
    buffer_store_dword v132, v11, s[12:15], s64 offen offset:384 sc1
    s_waitcnt lgkmcnt(6)
    v_mfma_f32_32x32x16_bf16 v[96:111], v[32:35], v[64:67], 0
    v_add_f32 v150, v118, v134
    v_add_f32 v151, v119, v135
    v_sub_f32 v134, v118, v134
    v_sub_f32 v135, v135, v119
    v_cvt_pk_bf16_f32 v118, v150, v151
    buffer_store_dword v118, v3, s[12:15], s50 offen offset:384 sc1
    v_cvt_pk_bf16_f32 v134, v134, v135
    buffer_store_dword v134, v11, s[12:15], s51 offen offset:384 sc1
    v_add_f32 v144, v120, v136
    v_add_f32 v145, v121, v137
    v_sub_f32 v136, v120, v136
    v_sub_f32 v137, v137, v121
    v_cvt_pk_bf16_f32 v120, v144, v145
    buffer_store_dword v120, v3, s[12:15], s51 offen offset:384 sc1
    s_waitcnt lgkmcnt(4)
    v_mfma_f32_32x32x16_bf16 v[96:111], v[36:39], v[68:71], v[96:111]
    v_cvt_pk_bf16_f32 v136, v136, v137
    buffer_store_dword v136, v11, s[12:15], s50 offen offset:384 sc1
    v_add_f32 v146, v122, v138
    v_add_f32 v147, v123, v139
    v_sub_f32 v138, v122, v138
    v_sub_f32 v139, v139, v123
    v_cvt_pk_bf16_f32 v122, v146, v147
    buffer_store_dword v122, v3, s[12:15], s64 offen offset:384 sc1
    v_cvt_pk_bf16_f32 v138, v138, v139
    buffer_store_dword v138, v11, s[12:15], s49 offen offset:384 sc1
    s_waitcnt lgkmcnt(2)
    v_mfma_f32_32x32x16_bf16 v[96:111], v[40:43], v[72:75], v[96:111]
    v_add_f32 v148, v124, v140
    v_add_f32 v149, v125, v141
    v_sub_f32 v140, v124, v140
    v_sub_f32 v141, v141, v125
    v_cvt_pk_bf16_f32 v124, v148, v149
    buffer_store_dword v124, v3, s[12:15], s65 offen offset:384 sc1
    v_cvt_pk_bf16_f32 v140, v140, v141
    buffer_store_dword v140, v11, s[12:15], s48 offen offset:384 sc1
    v_add_f32 v150, v126, v142
    v_add_f32 v151, v127, v143
    v_sub_f32 v142, v126, v142
    v_sub_f32 v143, v143, v127
    v_cvt_pk_bf16_f32 v126, v150, v151
    buffer_store_dword v126, v3, s[12:15], s66 offen offset:384 sc1
    s_waitcnt lgkmcnt(0)
    v_mfma_f32_32x32x16_bf16 v[96:111], v[44:47], v[76:79], v[96:111]
    v_cvt_pk_bf16_f32 v142, v142, v143
    buffer_store_dword v142, v11, s[12:15], 0 offen offset:384 sc1
    s_nop 9
    v_fma_f32 v80, v96, s31, v80
    v_fma_f32 v81, v81, s31, v97
    v_cvt_pk_bf16_f32 v80, v80, v81
    buffer_store_dword v80, v12, s[12:15], s40 offen sc1
    v_fma_f32 v82, v98, s31, v82
    v_fma_f32 v83, v83, s31, v99
    v_cvt_pk_bf16_f32 v82, v82, v83
    buffer_store_dword v82, v12, s[12:15], s41 offen sc1
    v_fma_f32 v84, v100, s31, v84
    v_fma_f32 v85, v85, s31, v101
    v_cvt_pk_bf16_f32 v84, v84, v85
    buffer_store_dword v84, v12, s[12:15], s42 offen sc1
    v_fma_f32 v86, v102, s31, v86
    v_fma_f32 v87, v87, s31, v103
    v_cvt_pk_bf16_f32 v86, v86, v87
    buffer_store_dword v86, v12, s[12:15], s43 offen sc1
    v_fma_f32 v88, v104, s31, v88
    v_fma_f32 v89, v89, s31, v105
    v_cvt_pk_bf16_f32 v88, v88, v89
    buffer_store_dword v88, v12, s[12:15], s44 offen sc1
    v_fma_f32 v90, v106, s31, v90
    v_fma_f32 v91, v91, s31, v107
    v_cvt_pk_bf16_f32 v90, v90, v91
    buffer_store_dword v90, v12, s[12:15], s45 offen sc1
    v_fma_f32 v92, v108, s31, v92
    v_fma_f32 v93, v93, s31, v109
    v_cvt_pk_bf16_f32 v92, v92, v93
    buffer_store_dword v92, v12, s[12:15], s46 offen sc1
    v_fma_f32 v94, v110, s31, v94
    v_fma_f32 v95, v95, s31, v111
    v_cvt_pk_bf16_f32 v94, v94, v95
    buffer_store_dword v94, v12, s[12:15], s47 offen sc1
L_p1done:
    s_mov_b32 s56, s54
    s_mov_b32 s57, s55
    s_mov_b32 s58, 256
    s_mov_b32 s59, 0x00020000
    v_min_u32 v156, 4, v1
    v_lshlrev_b32 v156, 2, v156
    buffer_load_dword v157, v156, s[56:59], 0 offen sc1
    s_mul_i32 s3, s20, 11
    v_min_u32 v13, 10, v1
    v_add_u32 v13, s3, v13
    v_min_u32 v13, 41, v13
    s_mul_i32 s3, s37, 5376
    s_add_u32 s3, s3, 54525952
    v_lshl_add_u32 v13, v13, 7, s3
    s_waitcnt vmcnt(0)
L_spin_rdy:
    v_cmp_gt_u32 vcc, 1, v157
    s_add_u32 s67, s67, 1
    s_cmp_ge_u32 s67, 120000
    s_cbranch_scc1 L_go_rdy
    s_cbranch_vccz L_go_rdy
    s_sleep 8
    buffer_load_dword v157, v156, s[56:59], 0 offen sc1
    s_waitcnt vmcnt(0)
    s_branch L_spin_rdy
L_go_rdy:
    v_readlane_b32 s33, v157, 4
    v_readlane_b32 s24, v157, 0
    v_readlane_b32 s25, v157, 1
    v_readlane_b32 s26, v157, 2
    v_readlane_b32 s27, v157, 3
    s_cmp_eq_u32 s63, 1
    s_cselect_b32 s3, s23, s2
    s_lshl_b32 s3, s3, 7
    s_add_u32 s3, s3, 54525952
    v_mov_b32 v156, s3
    s_barrier
    s_cmp_lg_u32 s20, 0
    s_cbranch_scc1 L_sg_p1
    v_mov_b32 v157, s24
    s_mov_b32 s3, 0
    s_mov_b64 exec, 1
    buffer_store_dword v157, v156, s[12:15], s3 offen sc1
    s_mov_b64 exec, -1
L_sg_p1:
    s_add_u32 s21, s21, s33
    s_and_b32 s21, s21, 7
    s_lshl_b32 s36, s21, 3
    s_lshr_b32 s3, s22, 2
    s_add_u32 s36, s36, s3
    s_and_b32 s33, s36, 31
    s_lshl_b32 s33, s33, 14
    s_lshr_b32 s3, s36, 5
    s_lshl_b32 s3, s3, 13
    s_add_u32 s33, s33, s3
    s_and_b32 s3, s20, 1
    s_lshl_b32 s3, s3, 12
    s_add_u32 s33, s33, s3
    s_add_u32 s65, s33, 26214400
    s_lshr_b32 s3, s20, 1
    s_lshl_b32 s3, s3, 19
    s_add_u32 s33, s33, s3
    s_add_u32 s64, s33, 16777216
    s_mul_i32 s3, s37, 3145728
    s_add_u32 s38, s33, s3
    s_add_u32 s38, s38, 4194304
    s_lshl_b32 s39, s20, 12
    s_add_u32 s39, s39, 113664
    s_bitcmp1_b32 s20, 0
    s_cselect_b32 s3, 56, 64
    v_cmp_gt_u32 vcc, s3, v1
    v_or_b32 v8, 0x80000000, v2
    s_nop 0
    v_cndmask_b32 v12, v8, v2, vcc
    v_and_b32 v9, 7, v1
    v_mul_u32_u24 v4, 1152, v9
    v_bfe_u32 v11, v1, 3, 1
    v_lshl_add_u32 v4, v11, 5, v4
    v_lshrrev_b32 v9, 1, v9
    v_lshrrev_b32 v11, 4, v1
    v_xor_b32 v9, v9, v11
    v_and_b32 v8, 1, v9
    v_lshl_add_u32 v4, v8, 4, v4
    v_lshrrev_b32 v8, 1, v9
    v_lshl_add_u32 v4, v8, 6, v4
    s_lshr_b32 s33, s20, 1
    s_xor_b32 s34, s33, 1
    s_lshl_b32 s3, s34, 13
    s_add_u32 s3, s3, 113664
    v_add_u32 v5, s3, v4
    s_lshl_b32 s3, s33, 13
    s_add_u32 s3, s3, 113664
    v_add_u32 v4, s3, v4
    s_and_b32 s35, s37, 1
    s_mul_i32 s35, s35, 12582912
    s_and_b32 s3, s36, 31
    s_lshl_b32 s3, s3, 8
    s_add_u32 s35, s35, s3
    s_lshr_b32 s3, s36, 5
    s_lshl_b32 s3, s3, 14
    s_add_u32 s35, s35, s3
    s_lshr_b32 s3, s37, 1
    s_lshl_b32 s3, s3, 13
    s_add_u32 s35, s35, s3
    s_add_u32 s35, s35, 29360128
    s_xor_b32 s3, s35, 2105344
    s_cmp_eq_u32 s33, 0
    s_cselect_b32 s33, s35, s3
    s_cselect_b32 s34, s3, s35
    s_mul_i32 s3, s20, 65536
    s_add_u32 s34, s34, s3
    s_add_u32 s3, s33, s3
    v_lshl_add_u32 v6, v1, 2, s3
    v_lshl_add_u32 v7, v1, 2, s34
    s_and_b32 s3, s20, 1
    s_lshl_b32 s3, s3, 6
    s_add_u32 s3, s3, s33
    s_add_u32 s3, s3, 262144
    v_and_b32 v8, 15, v1
    v_lshl_add_u32 v8, v8, 2, s3
    v_lshrrev_b32 v9, 5, v1
    v_lshl_add_u32 v8, v9, 7, v8
    v_and_b32 v11, 1, v11
    v_mul_u32_u24 v9, 1179648, v11
    v_add_u32 v8, v8, v9
    v_lshlrev_b32 v11, 31, v11
    v_or_b32 v9, v8, v11
    s_mov_b32 s41, 294912
    s_mov_b32 s42, 589824
    s_mov_b32 s43, 884736
    s_mov_b32 s44, 1179648
    s_mov_b32 s45, 1474560
    s_mov_b32 s46, 1769472
    s_mov_b32 s47, 32768
    s_mov_b32 s48, 327680
    s_mov_b32 s49, 622592
    s_mov_b32 s50, 917504
    s_mov_b32 s51, 1212416
    s_mov_b32 s30, 1507328
    s_mov_b32 s31, 1802240
    s_mov_b32 s66, 0x80000000
    s_lshl_b32 s3, s37, 6
    s_add_u32 s3, s3, s36
    s_lshl_b32 s3, s3, 7
    s_add_u32 s3, s3, 54525952
    v_mov_b32 v156, s3
    s_cmp_eq_u32 s63, 0
    s_cbranch_scc1 L_havetab
    v_mov_b32 v32, v8
    v_mov_b32 v33, v9
    v_lshrrev_b32 v9, 5, v1
    v_lshlrev_b32 v8, 1, v9
    s_lshl_b32 s3, s20, 5
    s_add_u32 s3, s3, 1
    v_add_u32 v8, s3, v8
    v_cvt_f32_u32 v152, v8
    v_add_f32 v153, 0x41800000, v152
    v_and_b32 v8, 31, v1
    v_add_u32 v8, 2, v8
    v_cvt_f32_u32 v154, v8
    v_mul_f32 v154, 0x3b800000, v154
    s_lshl_b32 s3, s20, 11
    s_add_u32 s3, s3, 73728
    v_add_u32 v8, s3, v2
    v_add_u32 v15, 73728, v2
    s_mov_b32 s33, 0xbcb8aa3b
    s_mov_b32 s34, 0x3cb8aa3b
    v_mul_f32 v155, 4.0, v154
    v_mul_f32 v144, v152, v154
    v_add_f32 v146, v144, v155
    v_add_f32 v148, v146, v155
    v_add_f32 v150, v148, v155
    v_fract_f32 v144, v144
    v_fract_f32 v146, v146
    v_fract_f32 v148, v148
    v_fract_f32 v150, v150
    v_sin_f32 v145, v144
    v_cos_f32 v144, v144
    v_sin_f32 v147, v146
    v_cos_f32 v146, v146
    v_sin_f32 v149, v148
    v_cos_f32 v148, v148
    v_sin_f32 v151, v150
    v_cos_f32 v150, v150
    v_mul_f32 v145, s34, v145
    v_mul_f32 v144, s33, v144
    v_mul_f32 v147, s34, v147
    v_mul_f32 v146, s33, v146
    v_mul_f32 v149, s34, v149
    v_mul_f32 v148, s33, v148
    v_mul_f32 v151, s34, v151
    v_mul_f32 v150, s33, v150
    v_cvt_pk_bf16_f32 v40, v144, v145
    v_cvt_pk_bf16_f32 v41, v146, v147
    v_cvt_pk_bf16_f32 v42, v148, v149
    v_cvt_pk_bf16_f32 v43, v150, v151
    ds_write_b128 v8, v[40:43] offset:0
    v_mul_f32 v144, v153, v154
    v_add_f32 v146, v144, v155
    v_add_f32 v148, v146, v155
    v_add_f32 v150, v148, v155
    v_fract_f32 v144, v144
    v_fract_f32 v146, v146
    v_fract_f32 v148, v148
    v_fract_f32 v150, v150
    v_sin_f32 v145, v144
    v_cos_f32 v144, v144
    v_sin_f32 v147, v146
    v_cos_f32 v146, v146
    v_sin_f32 v149, v148
    v_cos_f32 v148, v148
    v_sin_f32 v151, v150
    v_cos_f32 v150, v150
    v_mul_f32 v145, s34, v145
    v_mul_f32 v144, s33, v144
    v_mul_f32 v147, s34, v147
    v_mul_f32 v146, s33, v146
    v_mul_f32 v149, s34, v149
    v_mul_f32 v148, s33, v148
    v_mul_f32 v151, s34, v151
    v_mul_f32 v150, s33, v150
    v_cvt_pk_bf16_f32 v44, v144, v145
    v_cvt_pk_bf16_f32 v45, v146, v147
    v_cvt_pk_bf16_f32 v46, v148, v149
    v_cvt_pk_bf16_f32 v47, v150, v151
    ds_write_b128 v8, v[44:47] offset:1024
    v_add_f32 v154, 0x3e000000, v154
    v_mul_f32 v155, 4.0, v154
    v_mul_f32 v144, v152, v154
    v_add_f32 v146, v144, v155
    v_add_f32 v148, v146, v155
    v_add_f32 v150, v148, v155
    v_fract_f32 v144, v144
    v_fract_f32 v146, v146
    v_fract_f32 v148, v148
    v_fract_f32 v150, v150
    v_sin_f32 v145, v144
    v_cos_f32 v144, v144
    v_sin_f32 v147, v146
    v_cos_f32 v146, v146
    v_sin_f32 v149, v148
    v_cos_f32 v148, v148
    v_sin_f32 v151, v150
    v_cos_f32 v150, v150
    v_mul_f32 v145, s34, v145
    v_mul_f32 v144, s33, v144
    v_mul_f32 v147, s34, v147
    v_mul_f32 v146, s33, v146
    v_mul_f32 v149, s34, v149
    v_mul_f32 v148, s33, v148
    v_mul_f32 v151, s34, v151
    v_mul_f32 v150, s33, v150
    v_cvt_pk_bf16_f32 v48, v144, v145
    v_cvt_pk_bf16_f32 v49, v146, v147
    v_cvt_pk_bf16_f32 v50, v148, v149
    v_cvt_pk_bf16_f32 v51, v150, v151
    ds_write_b128 v8, v[48:51] offset:8192
    v_mul_f32 v144, v153, v154
    v_add_f32 v146, v144, v155
    v_add_f32 v148, v146, v155
    v_add_f32 v150, v148, v155
    v_fract_f32 v144, v144
    v_fract_f32 v146, v146
    v_fract_f32 v148, v148
    v_fract_f32 v150, v150
    v_sin_f32 v145, v144
    v_cos_f32 v144, v144
    v_sin_f32 v147, v146
    v_cos_f32 v146, v146
    v_sin_f32 v149, v148
    v_cos_f32 v148, v148
    v_sin_f32 v151, v150
    v_cos_f32 v150, v150
    v_mul_f32 v145, s34, v145
    v_mul_f32 v144, s33, v144
    v_mul_f32 v147, s34, v147
    v_mul_f32 v146, s33, v146
    v_mul_f32 v149, s34, v149
    v_mul_f32 v148, s33, v148
    v_mul_f32 v151, s34, v151
    v_mul_f32 v150, s33, v150
    v_cvt_pk_bf16_f32 v52, v144, v145
    v_cvt_pk_bf16_f32 v53, v146, v147
    v_cvt_pk_bf16_f32 v54, v148, v149
    v_cvt_pk_bf16_f32 v55, v150, v151
    ds_write_b128 v8, v[52:55] offset:9216
    v_add_f32 v154, 0x3e000000, v154
    v_mul_f32 v155, 4.0, v154
    v_mul_f32 v144, v152, v154
    v_add_f32 v146, v144, v155
    v_add_f32 v148, v146, v155
    v_add_f32 v150, v148, v155
    v_fract_f32 v144, v144
    v_fract_f32 v146, v146
    v_fract_f32 v148, v148
    v_fract_f32 v150, v150
    v_sin_f32 v145, v144
    v_cos_f32 v144, v144
    v_sin_f32 v147, v146
    v_cos_f32 v146, v146
    v_sin_f32 v149, v148
    v_cos_f32 v148, v148
    v_sin_f32 v151, v150
    v_cos_f32 v150, v150
    v_mul_f32 v145, s34, v145
    v_mul_f32 v144, s33, v144
    v_mul_f32 v147, s34, v147
    v_mul_f32 v146, s33, v146
    v_mul_f32 v149, s34, v149
    v_mul_f32 v148, s33, v148
    v_mul_f32 v151, s34, v151
    v_mul_f32 v150, s33, v150
    v_cvt_pk_bf16_f32 v56, v144, v145
    v_cvt_pk_bf16_f32 v57, v146, v147
    v_cvt_pk_bf16_f32 v58, v148, v149
    v_cvt_pk_bf16_f32 v59, v150, v151
    ds_write_b128 v8, v[56:59] offset:16384
    v_mul_f32 v144, v153, v154
    v_add_f32 v146, v144, v155
    v_add_f32 v148, v146, v155
    v_add_f32 v150, v148, v155
    v_fract_f32 v144, v144
    v_fract_f32 v146, v146
    v_fract_f32 v148, v148
    v_fract_f32 v150, v150
    v_sin_f32 v145, v144
    v_cos_f32 v144, v144
    v_sin_f32 v147, v146
    v_cos_f32 v146, v146
    v_sin_f32 v149, v148
    v_cos_f32 v148, v148
    v_sin_f32 v151, v150
    v_cos_f32 v150, v150
    v_mul_f32 v145, s34, v145
    v_mul_f32 v144, s33, v144
    v_mul_f32 v147, s34, v147
    v_mul_f32 v146, s33, v146
    v_mul_f32 v149, s34, v149
    v_mul_f32 v148, s33, v148
    v_mul_f32 v151, s34, v151
    v_mul_f32 v150, s33, v150
    v_cvt_pk_bf16_f32 v60, v144, v145
    v_cvt_pk_bf16_f32 v61, v146, v147
    v_cvt_pk_bf16_f32 v62, v148, v149
    v_cvt_pk_bf16_f32 v63, v150, v151
    ds_write_b128 v8, v[60:63] offset:17408
    buffer_load_dword v155, v13, s[12:15], 0 offen sc1
    v_mov_b32 v8, v32
    v_mov_b32 v9, v33
    s_waitcnt lgkmcnt(0)
    s_barrier
    ds_read_b128 a[180:183], v15 offset:0
    ds_read_b128 a[184:187], v15 offset:1024
    ds_read_b128 a[188:191], v15 offset:2048
    ds_read_b128 a[192:195], v15 offset:3072
    ds_read_b128 a[196:199], v15 offset:4096
    ds_read_b128 a[200:203], v15 offset:5120
    ds_read_b128 a[204:207], v15 offset:6144
    ds_read_b128 a[208:211], v15 offset:7168
    ds_read_b128 a[212:215], v15 offset:8192
    ds_read_b128 a[216:219], v15 offset:9216
    ds_read_b128 a[220:223], v15 offset:10240
    ds_read_b128 a[224:227], v15 offset:11264
    s_waitcnt lgkmcnt(2)
    ds_read_b128 a[228:231], v15 offset:12288
    ds_read_b128 a[232:235], v15 offset:13312
    ds_read_b128 a[236:239], v15 offset:14336
    ds_read_b128 a[240:243], v15 offset:15360
    ds_read_b128 a[244:247], v15 offset:16384
    ds_read_b128 a[248:251], v15 offset:17408
    ds_read_b128 a[252:255], v15 offset:18432
    ds_read_b128 v[236:239], v15 offset:19456
    ds_read_b128 v[240:243], v15 offset:20480
    ds_read_b128 v[244:247], v15 offset:21504
    ds_read_b128 v[248:251], v15 offset:22528
    ds_read_b128 v[252:255], v15 offset:23552
    s_waitcnt lgkmcnt(8)
    s_waitcnt vmcnt(0)
    s_branch L_pollx
L_havetab:
    s_cmp_lt_u32 s2, 249
    s_cbranch_scc1 L_go_sp
    v_mov_b32 v155, 0
    v_readfirstlane_b32 s3, v13
    s_nop 1
    v_mov_b32 v154, s3
L_spin_sp:
    v_cmp_ne_u32 vcc, s24, v155
    s_add_u32 s67, s67, 1
    s_cmp_ge_u32 s67, 120000
    s_cbranch_scc1 L_go_sp
    s_cbranch_vccz L_go_sp
    s_sleep 24
    buffer_load_dword v155, v154, s[12:15], 0 offen sc1
    s_waitcnt vmcnt(0)
    s_branch L_spin_sp
L_go_sp:
    buffer_load_dword v155, v13, s[12:15], 0 offen sc1
    s_waitcnt vmcnt(0)
L_pollx:
L_spin_px:
    v_cmp_ne_u32 vcc, s24, v155
    s_add_u32 s67, s67, 1
    s_cmp_ge_u32 s67, 120000
    s_cbranch_scc1 L_go_px
    s_cbranch_vccz L_go_px
    s_sleep 16
    buffer_load_dword v155, v13, s[12:15], 0 offen sc1
    s_waitcnt vmcnt(0)
    s_branch L_spin_px
L_go_px:
    s_mul_i32 s3, s20, 21
    v_min_u32 v13, 20, v1
    v_add_u32 v13, s3, v13
    v_min_u32 v13, 80, v13
    v_lshlrev_b32 v13, 7, v13
    v_add_u32 v13, 54547456, v13
    s_barrier
    s_add_u32 m0, s39, 0
    s_add_u32 s35, s38, 0
    s_lshr_b32 s3, s35, 8
    s_and_b32 s3, s3, 8192
    s_xor_b32 s35, s35, s3
    buffer_load_dwordx4 v2, s[12:15], s35 offen offset:0 sc1 lds
    buffer_load_dwordx4 v2, s[12:15], s35 offen offset:1024 sc1 lds
    buffer_load_dwordx4 v2, s[12:15], s35 offen offset:2048 sc1 lds
    buffer_load_dwordx4 v12, s[12:15], s35 offen offset:3072 sc1 lds
    s_add_u32 m0, s39, 16384
    s_add_u32 s35, s38, 1048576
    s_lshr_b32 s3, s35, 8
    s_and_b32 s3, s3, 8192
    s_xor_b32 s35, s35, s3
    buffer_load_dwordx4 v2, s[12:15], s35 offen offset:0 sc1 lds
    buffer_load_dwordx4 v2, s[12:15], s35 offen offset:1024 sc1 lds
    buffer_load_dwordx4 v2, s[12:15], s35 offen offset:2048 sc1 lds
    buffer_load_dwordx4 v12, s[12:15], s35 offen offset:3072 sc1 lds
    buffer_load_dword v155, v13, s[12:15], 0 offen sc1
    s_waitcnt vmcnt(0)
L_spin_pw:
    v_cmp_ne_u32 vcc, s24, v155
    s_add_u32 s67, s67, 1
    s_cmp_ge_u32 s67, 120000
    s_cbranch_scc1 L_go_pw
    s_cbranch_vccz L_go_pw
    s_sleep 2
    buffer_load_dword v155, v13, s[12:15], 0 offen sc1
    s_waitcnt vmcnt(0)
    s_branch L_spin_pw
L_go_pw:
    s_barrier
    buffer_load_dwordx4 a[0:3], v2, s[12:15], s64 offen offset:0 sc1
    buffer_load_dwordx4 a[36:39], v2, s[12:15], s64 offen offset:1024 sc1
    buffer_load_dwordx4 a[72:75], v2, s[12:15], s64 offen offset:2048 sc1
    buffer_load_dwordx4 a[108:111], v2, s[12:15], s64 offen offset:3072 sc1
    buffer_load_dwordx4 a[144:147], v2, s[12:15], s65 offen offset:0 sc1
    s_add_u32 s64, s64, 0x100000
    buffer_load_dwordx4 a[4:7], v2, s[12:15], s64 offen offset:0 sc1
    buffer_load_dwordx4 a[40:43], v2, s[12:15], s64 offen offset:1024 sc1
    buffer_load_dwordx4 a[76:79], v2, s[12:15], s64 offen offset:2048 sc1
    buffer_load_dwordx4 a[112:115], v2, s[12:15], s64 offen offset:3072 sc1
    buffer_load_dwordx4 a[148:151], v2, s[12:15], s65 offen offset:1024 sc1
    s_add_u32 s64, s64, 0x100000
    s_xor_b32 s64, s64, 8192
    buffer_load_dwordx4 a[8:11], v2, s[12:15], s64 offen offset:0 sc1
    buffer_load_dwordx4 a[44:47], v2, s[12:15], s64 offen offset:1024 sc1
    buffer_load_dwordx4 a[80:83], v2, s[12:15], s64 offen offset:2048 sc1
    s_lshr_b32 s28, s21, 1
    s_and_b32 s23, s21, 1
    s_lshl_b32 s23, s23, 5
    s_add_u32 s23, s23, s22
    s_lshl_b32 s23, s23, 2
    s_add_u32 s3, s23, s20
    s_mul_i32 s29, s3, 3641
    s_lshr_b32 s29, s29, 16
    s_mul_i32 s29, s29, 9
    s_sub_u32 s3, s3, s29
    s_sub_u32 s32, s3, s29
    s_cmp_ge_u32 s32, 9
    s_cselect_b32 s32, 1, 0
    s_cselect_b32 s29, 9, 0
    s_sub_u32 s29, s3, s29
    s_lshl_b32 s3, s28, 2
    s_add_u32 s3, s3, s20
    s_lshl_b32 s3, s3, 11
    s_add_u32 s3, s3, 54558720
    v_and_b32 v13, 15, v1
    v_lshl_add_u32 v13, v13, 7, s3
    ds_read_b128 v[16:19], v4 offset:0
    ds_read_b128 v[20:23], v5 offset:0
    ds_read_b128 v[24:27], v4 offset:128
    s_waitcnt vmcnt(8)
    s_waitcnt lgkmcnt(2)
    v_mfma_f32_16x16x32_bf16 v[40:43], v[16:19], a[0:3], 0
    v_pk_add_u16 v32, v16, s66 op_sel:[1,0] op_sel_hi:[0,1]
    v_pk_add_u16 v33, v17, s66 op_sel:[1,0] op_sel_hi:[0,1]
    v_mfma_f32_16x16x32_bf16 v[48:51], v[16:19], a[36:39], 0
    v_pk_add_u16 v34, v18, s66 op_sel:[1,0] op_sel_hi:[0,1]
    v_pk_add_u16 v35, v19, s66 op_sel:[1,0] op_sel_hi:[0,1]
    v_mfma_f32_16x16x32_bf16 v[56:59], v[16:19], a[72:75], 0
    ds_read_b128 v[28:31], v5 offset:128
    v_mfma_f32_16x16x32_bf16 v[64:67], v[16:19], a[108:111], 0
    v_mfma_f32_16x16x32_bf16 v[72:75], v[16:19], a[144:147], 0
    v_mfma_f32_16x16x32_bf16 v[44:47], v[32:35], a[0:3], 0
    buffer_load_dwordx4 a[116:119], v2, s[12:15], s64 offen offset:3072 sc1
    v_mfma_f32_16x16x32_bf16 v[52:55], v[32:35], a[36:39], 0
    buffer_load_dwordx4 a[152:155], v2, s[12:15], s65 offen offset:2048 sc1
    v_mfma_f32_16x16x32_bf16 v[60:63], v[32:35], a[72:75], 0
    s_add_u32 s64, s64, 0x100000
    buffer_load_dwordx4 a[12:15], v2, s[12:15], s64 offen offset:0 sc1
    v_mfma_f32_16x16x32_bf16 v[68:71], v[32:35], a[108:111], 0
    v_mfma_f32_16x16x32_bf16 v[76:79], v[32:35], a[144:147], 0
    s_waitcnt lgkmcnt(2)
    v_mfma_f32_16x16x32_bf16 v[80:83], v[20:23], a[0:3], 0
    v_pk_add_u16 v32, v20, s66 op_sel:[1,0] op_sel_hi:[0,1]
    v_pk_add_u16 v33, v21, s66 op_sel:[1,0] op_sel_hi:[0,1]
    v_mfma_f32_16x16x32_bf16 v[88:91], v[20:23], a[36:39], 0
    v_pk_add_u16 v34, v22, s66 op_sel:[1,0] op_sel_hi:[0,1]
    v_pk_add_u16 v35, v23, s66 op_sel:[1,0] op_sel_hi:[0,1]
    v_mfma_f32_16x16x32_bf16 v[96:99], v[20:23], a[72:75], 0
    ds_read_b128 v[16:19], v4 offset:256
    v_mfma_f32_16x16x32_bf16 v[104:107], v[20:23], a[108:111], 0
    v_mfma_f32_16x16x32_bf16 v[84:87], v[32:35], a[0:3], 0
    buffer_load_dwordx4 a[48:51], v2, s[12:15], s64 offen offset:1024 sc1
    v_mfma_f32_16x16x32_bf16 v[92:95], v[32:35], a[36:39], 0
    buffer_load_dwordx4 a[84:87], v2, s[12:15], s64 offen offset:2048 sc1
    v_mfma_f32_16x16x32_bf16 v[100:103], v[32:35], a[72:75], 0
    buffer_load_dwordx4 a[120:123], v2, s[12:15], s64 offen offset:3072 sc1
    v_mfma_f32_16x16x32_bf16 v[108:111], v[32:35], a[108:111], 0
    s_waitcnt vmcnt(9)
    s_waitcnt lgkmcnt(2)
    v_mfma_f32_16x16x32_bf16 v[40:43], v[24:27], a[4:7], v[40:43]
    v_pk_add_u16 v32, v24, s66 op_sel:[1,0] op_sel_hi:[0,1]
    v_pk_add_u16 v33, v25, s66 op_sel:[1,0] op_sel_hi:[0,1]
    v_mfma_f32_16x16x32_bf16 v[48:51], v[24:27], a[40:43], v[48:51]
    v_pk_add_u16 v34, v26, s66 op_sel:[1,0] op_sel_hi:[0,1]
    v_pk_add_u16 v35, v27, s66 op_sel:[1,0] op_sel_hi:[0,1]
    v_mfma_f32_16x16x32_bf16 v[56:59], v[24:27], a[76:79], v[56:59]
    ds_read_b128 v[20:23], v5 offset:256
    v_mfma_f32_16x16x32_bf16 v[64:67], v[24:27], a[112:115], v[64:67]
    v_mfma_f32_16x16x32_bf16 v[72:75], v[24:27], a[148:151], v[72:75]
    v_mfma_f32_16x16x32_bf16 v[44:47], v[32:35], a[4:7], v[44:47]
    buffer_load_dwordx4 a[156:159], v2, s[12:15], s65 offen offset:3072 sc1
    v_mfma_f32_16x16x32_bf16 v[52:55], v[32:35], a[40:43], v[52:55]
    s_add_u32 s64, s64, 0x100000
    s_xor_b32 s64, s64, 8192
    buffer_load_dwordx4 a[16:19], v2, s[12:15], s64 offen offset:0 sc1
    v_mfma_f32_16x16x32_bf16 v[60:63], v[32:35], a[76:79], v[60:63]
    buffer_load_dwordx4 a[52:55], v2, s[12:15], s64 offen offset:1024 sc1
    v_mfma_f32_16x16x32_bf16 v[68:71], v[32:35], a[112:115], v[68:71]
    v_mfma_f32_16x16x32_bf16 v[76:79], v[32:35], a[148:151], v[76:79]
    s_waitcnt lgkmcnt(2)
    v_mfma_f32_16x16x32_bf16 v[80:83], v[28:31], a[4:7], v[80:83]
    v_pk_add_u16 v32, v28, s66 op_sel:[1,0] op_sel_hi:[0,1]
    v_pk_add_u16 v33, v29, s66 op_sel:[1,0] op_sel_hi:[0,1]
    v_mfma_f32_16x16x32_bf16 v[88:91], v[28:31], a[40:43], v[88:91]
    v_pk_add_u16 v34, v30, s66 op_sel:[1,0] op_sel_hi:[0,1]
    v_pk_add_u16 v35, v31, s66 op_sel:[1,0] op_sel_hi:[0,1]
    v_mfma_f32_16x16x32_bf16 v[96:99], v[28:31], a[76:79], v[96:99]
    ds_read_b128 v[24:27], v4 offset:384
    v_mfma_f32_16x16x32_bf16 v[104:107], v[28:31], a[112:115], v[104:107]
    v_mfma_f32_16x16x32_bf16 v[84:87], v[32:35], a[4:7], v[84:87]
    buffer_load_dwordx4 a[88:91], v2, s[12:15], s64 offen offset:2048 sc1
    v_mfma_f32_16x16x32_bf16 v[92:95], v[32:35], a[40:43], v[92:95]
    buffer_load_dwordx4 a[124:127], v2, s[12:15], s64 offen offset:3072 sc1
    v_mfma_f32_16x16x32_bf16 v[100:103], v[32:35], a[76:79], v[100:103]
    s_add_u32 s65, s65, 0x80000
    buffer_load_dwordx4 a[160:163], v2, s[12:15], s65 offen offset:0 sc1
    v_mfma_f32_16x16x32_bf16 v[108:111], v[32:35], a[112:115], v[108:111]
    s_waitcnt vmcnt(10)
    s_waitcnt lgkmcnt(2)
    v_mfma_f32_16x16x32_bf16 v[40:43], v[16:19], a[8:11], v[40:43]
    v_pk_add_u16 v32, v16, s66 op_sel:[1,0] op_sel_hi:[0,1]
    v_pk_add_u16 v33, v17, s66 op_sel:[1,0] op_sel_hi:[0,1]
    v_mfma_f32_16x16x32_bf16 v[48:51], v[16:19], a[44:47], v[48:51]
    v_pk_add_u16 v34, v18, s66 op_sel:[1,0] op_sel_hi:[0,1]
    v_pk_add_u16 v35, v19, s66 op_sel:[1,0] op_sel_hi:[0,1]
    v_mfma_f32_16x16x32_bf16 v[56:59], v[16:19], a[80:83], v[56:59]
    ds_read_b128 v[28:31], v5 offset:384
    v_mfma_f32_16x16x32_bf16 v[64:67], v[16:19], a[116:119], v[64:67]
    v_mfma_f32_16x16x32_bf16 v[72:75], v[16:19], a[152:155], v[72:75]
    v_mfma_f32_16x16x32_bf16 v[44:47], v[32:35], a[8:11], v[44:47]
    s_add_u32 s64, s64, 0x100000
    buffer_load_dwordx4 a[20:23], v2, s[12:15], s64 offen offset:0 sc1
    v_mfma_f32_16x16x32_bf16 v[52:55], v[32:35], a[44:47], v[52:55]
    buffer_load_dwordx4 a[56:59], v2, s[12:15], s64 offen offset:1024 sc1
    v_mfma_f32_16x16x32_bf16 v[60:63], v[32:35], a[80:83], v[60:63]
    buffer_load_dwordx4 a[92:95], v2, s[12:15], s64 offen offset:2048 sc1
    v_mfma_f32_16x16x32_bf16 v[68:71], v[32:35], a[116:119], v[68:71]
    v_mfma_f32_16x16x32_bf16 v[76:79], v[32:35], a[152:155], v[76:79]
    s_waitcnt lgkmcnt(2)
    v_mfma_f32_16x16x32_bf16 v[80:83], v[20:23], a[8:11], v[80:83]
    v_pk_add_u16 v32, v20, s66 op_sel:[1,0] op_sel_hi:[0,1]
    v_pk_add_u16 v33, v21, s66 op_sel:[1,0] op_sel_hi:[0,1]
    v_mfma_f32_16x16x32_bf16 v[88:91], v[20:23], a[44:47], v[88:91]
    v_pk_add_u16 v34, v22, s66 op_sel:[1,0] op_sel_hi:[0,1]
    v_pk_add_u16 v35, v23, s66 op_sel:[1,0] op_sel_hi:[0,1]
    v_mfma_f32_16x16x32_bf16 v[96:99], v[20:23], a[80:83], v[96:99]
    ds_read_b128 v[16:19], v4 offset:512
    v_mfma_f32_16x16x32_bf16 v[104:107], v[20:23], a[116:119], v[104:107]
    v_mfma_f32_16x16x32_bf16 v[84:87], v[32:35], a[8:11], v[84:87]
    buffer_load_dwordx4 a[128:131], v2, s[12:15], s64 offen offset:3072 sc1
    v_mfma_f32_16x16x32_bf16 v[92:95], v[32:35], a[44:47], v[92:95]
    buffer_load_dwordx4 a[164:167], v2, s[12:15], s65 offen offset:1024 sc1
    v_mfma_f32_16x16x32_bf16 v[100:103], v[32:35], a[80:83], v[100:103]
    s_add_u32 s64, s64, 0x100000
    s_xor_b32 s64, s64, 8192
    buffer_load_dwordx4 a[24:27], v2, s[12:15], s64 offen offset:0 sc1
    v_mfma_f32_16x16x32_bf16 v[108:111], v[32:35], a[116:119], v[108:111]
    s_waitcnt vmcnt(11)
    s_waitcnt lgkmcnt(2)
    v_mfma_f32_16x16x32_bf16 v[40:43], v[24:27], a[12:15], v[40:43]
    v_pk_add_u16 v32, v24, s66 op_sel:[1,0] op_sel_hi:[0,1]
    v_pk_add_u16 v33, v25, s66 op_sel:[1,0] op_sel_hi:[0,1]
    v_mfma_f32_16x16x32_bf16 v[48:51], v[24:27], a[48:51], v[48:51]
    v_pk_add_u16 v34, v26, s66 op_sel:[1,0] op_sel_hi:[0,1]
    v_pk_add_u16 v35, v27, s66 op_sel:[1,0] op_sel_hi:[0,1]
    v_mfma_f32_16x16x32_bf16 v[56:59], v[24:27], a[84:87], v[56:59]
    ds_read_b128 v[20:23], v5 offset:512
    v_mfma_f32_16x16x32_bf16 v[64:67], v[24:27], a[120:123], v[64:67]
    v_mfma_f32_16x16x32_bf16 v[72:75], v[24:27], a[156:159], v[72:75]
    v_mfma_f32_16x16x32_bf16 v[44:47], v[32:35], a[12:15], v[44:47]
    buffer_load_dwordx4 a[60:63], v2, s[12:15], s64 offen offset:1024 sc1
    v_mfma_f32_16x16x32_bf16 v[52:55], v[32:35], a[48:51], v[52:55]
    buffer_load_dwordx4 a[96:99], v2, s[12:15], s64 offen offset:2048 sc1
    v_mfma_f32_16x16x32_bf16 v[60:63], v[32:35], a[84:87], v[60:63]
    buffer_load_dwordx4 a[132:135], v2, s[12:15], s64 offen offset:3072 sc1
    v_mfma_f32_16x16x32_bf16 v[68:71], v[32:35], a[120:123], v[68:71]
    v_mfma_f32_16x16x32_bf16 v[76:79], v[32:35], a[156:159], v[76:79]
    s_waitcnt lgkmcnt(2)
    v_mfma_f32_16x16x32_bf16 v[80:83], v[28:31], a[12:15], v[80:83]
    v_pk_add_u16 v32, v28, s66 op_sel:[1,0] op_sel_hi:[0,1]
    v_pk_add_u16 v33, v29, s66 op_sel:[1,0] op_sel_hi:[0,1]
    v_mfma_f32_16x16x32_bf16 v[88:91], v[28:31], a[48:51], v[88:91]
    v_pk_add_u16 v34, v30, s66 op_sel:[1,0] op_sel_hi:[0,1]
    v_pk_add_u16 v35, v31, s66 op_sel:[1,0] op_sel_hi:[0,1]
    v_mfma_f32_16x16x32_bf16 v[96:99], v[28:31], a[84:87], v[96:99]
    ds_read_b128 v[24:27], v4 offset:640
    v_mfma_f32_16x16x32_bf16 v[104:107], v[28:31], a[120:123], v[104:107]
    v_mfma_f32_16x16x32_bf16 v[84:87], v[32:35], a[12:15], v[84:87]
    buffer_load_dwordx4 a[168:171], v2, s[12:15], s65 offen offset:2048 sc1
    v_mfma_f32_16x16x32_bf16 v[92:95], v[32:35], a[48:51], v[92:95]
    s_add_u32 s64, s64, 0x100000
    buffer_load_dwordx4 a[28:31], v2, s[12:15], s64 offen offset:0 sc1
    v_mfma_f32_16x16x32_bf16 v[100:103], v[32:35], a[84:87], v[100:103]
    buffer_load_dwordx4 a[64:67], v2, s[12:15], s64 offen offset:1024 sc1
    v_mfma_f32_16x16x32_bf16 v[108:111], v[32:35], a[120:123], v[108:111]
    s_waitcnt vmcnt(12)
    s_waitcnt lgkmcnt(2)
    v_mfma_f32_16x16x32_bf16 v[40:43], v[16:19], a[16:19], v[40:43]
    v_pk_add_u16 v32, v16, s66 op_sel:[1,0] op_sel_hi:[0,1]
    v_pk_add_u16 v33, v17, s66 op_sel:[1,0] op_sel_hi:[0,1]
    v_mfma_f32_16x16x32_bf16 v[48:51], v[16:19], a[52:55], v[48:51]
    v_pk_add_u16 v34, v18, s66 op_sel:[1,0] op_sel_hi:[0,1]
    v_pk_add_u16 v35, v19, s66 op_sel:[1,0] op_sel_hi:[0,1]
    v_mfma_f32_16x16x32_bf16 v[56:59], v[16:19], a[88:91], v[56:59]
    ds_read_b128 v[28:31], v5 offset:640
    v_mfma_f32_16x16x32_bf16 v[64:67], v[16:19], a[124:127], v[64:67]
    v_mfma_f32_16x16x32_bf16 v[72:75], v[16:19], a[160:163], v[72:75]
    v_mfma_f32_16x16x32_bf16 v[44:47], v[32:35], a[16:19], v[44:47]
    buffer_load_dwordx4 a[100:103], v2, s[12:15], s64 offen offset:2048 sc1
    v_mfma_f32_16x16x32_bf16 v[52:55], v[32:35], a[52:55], v[52:55]
    buffer_load_dwordx4 a[136:139], v2, s[12:15], s64 offen offset:3072 sc1
    v_mfma_f32_16x16x32_bf16 v[60:63], v[32:35], a[88:91], v[60:63]
    buffer_load_dwordx4 a[172:175], v2, s[12:15], s65 offen offset:3072 sc1
    v_mfma_f32_16x16x32_bf16 v[68:71], v[32:35], a[124:127], v[68:71]
    v_mfma_f32_16x16x32_bf16 v[76:79], v[32:35], a[160:163], v[76:79]
    s_waitcnt lgkmcnt(2)
    v_mfma_f32_16x16x32_bf16 v[80:83], v[20:23], a[16:19], v[80:83]
    v_pk_add_u16 v32, v20, s66 op_sel:[1,0] op_sel_hi:[0,1]
    v_pk_add_u16 v33, v21, s66 op_sel:[1,0] op_sel_hi:[0,1]
    v_mfma_f32_16x16x32_bf16 v[88:91], v[20:23], a[52:55], v[88:91]
    v_pk_add_u16 v34, v22, s66 op_sel:[1,0] op_sel_hi:[0,1]
    v_pk_add_u16 v35, v23, s66 op_sel:[1,0] op_sel_hi:[0,1]
    v_mfma_f32_16x16x32_bf16 v[96:99], v[20:23], a[88:91], v[96:99]
    ds_read_b128 v[16:19], v4 offset:768
    v_mfma_f32_16x16x32_bf16 v[104:107], v[20:23], a[124:127], v[104:107]
    v_mfma_f32_16x16x32_bf16 v[84:87], v[32:35], a[16:19], v[84:87]
    s_add_u32 s64, s64, 0x100000
    s_xor_b32 s64, s64, 8192
    buffer_load_dwordx4 a[32:35], v2, s[12:15], s64 offen offset:0 sc1
    v_mfma_f32_16x16x32_bf16 v[92:95], v[32:35], a[52:55], v[92:95]
    buffer_load_dwordx4 a[68:71], v2, s[12:15], s64 offen offset:1024 sc1
    v_mfma_f32_16x16x32_bf16 v[100:103], v[32:35], a[88:91], v[100:103]
    buffer_load_dwordx4 a[104:107], v2, s[12:15], s64 offen offset:2048 sc1
    v_mfma_f32_16x16x32_bf16 v[108:111], v[32:35], a[124:127], v[108:111]
    s_waitcnt vmcnt(13)
    s_waitcnt lgkmcnt(2)
    v_mfma_f32_16x16x32_bf16 v[40:43], v[24:27], a[20:23], v[40:43]
    v_pk_add_u16 v32, v24, s66 op_sel:[1,0] op_sel_hi:[0,1]
    v_pk_add_u16 v33, v25, s66 op_sel:[1,0] op_sel_hi:[0,1]
    v_mfma_f32_16x16x32_bf16 v[48:51], v[24:27], a[56:59], v[48:51]
    v_pk_add_u16 v34, v26, s66 op_sel:[1,0] op_sel_hi:[0,1]
    v_pk_add_u16 v35, v27, s66 op_sel:[1,0] op_sel_hi:[0,1]
    v_mfma_f32_16x16x32_bf16 v[56:59], v[24:27], a[92:95], v[56:59]
    ds_read_b128 v[20:23], v5 offset:768
    v_mfma_f32_16x16x32_bf16 v[64:67], v[24:27], a[128:131], v[64:67]
    v_mfma_f32_16x16x32_bf16 v[72:75], v[24:27], a[164:167], v[72:75]
    v_mfma_f32_16x16x32_bf16 v[44:47], v[32:35], a[20:23], v[44:47]
    buffer_load_dwordx4 a[140:143], v2, s[12:15], s64 offen offset:3072 sc1
    v_mfma_f32_16x16x32_bf16 v[52:55], v[32:35], a[56:59], v[52:55]
    s_add_u32 s65, s65, 0x80000
    s_xor_b32 s65, s65, 8192
    buffer_load_dwordx4 a[176:179], v2, s[12:15], s65 offen offset:0 sc1
    v_mfma_f32_16x16x32_bf16 v[60:63], v[32:35], a[92:95], v[60:63]
    v_mfma_f32_16x16x32_bf16 v[68:71], v[32:35], a[128:131], v[68:71]
    v_mfma_f32_16x16x32_bf16 v[76:79], v[32:35], a[164:167], v[76:79]
    s_waitcnt lgkmcnt(2)
    v_mfma_f32_16x16x32_bf16 v[80:83], v[28:31], a[20:23], v[80:83]
    v_pk_add_u16 v32, v28, s66 op_sel:[1,0] op_sel_hi:[0,1]
    v_pk_add_u16 v33, v29, s66 op_sel:[1,0] op_sel_hi:[0,1]
    v_mfma_f32_16x16x32_bf16 v[88:91], v[28:31], a[56:59], v[88:91]
    v_pk_add_u16 v34, v30, s66 op_sel:[1,0] op_sel_hi:[0,1]
    v_pk_add_u16 v35, v31, s66 op_sel:[1,0] op_sel_hi:[0,1]
    v_mfma_f32_16x16x32_bf16 v[96:99], v[28:31], a[92:95], v[96:99]
    ds_read_b128 v[24:27], v4 offset:896
    v_mfma_f32_16x16x32_bf16 v[104:107], v[28:31], a[128:131], v[104:107]
    v_mfma_f32_16x16x32_bf16 v[84:87], v[32:35], a[20:23], v[84:87]
    v_mfma_f32_16x16x32_bf16 v[92:95], v[32:35], a[56:59], v[92:95]
    v_mfma_f32_16x16x32_bf16 v[100:103], v[32:35], a[92:95], v[100:103]
    v_mfma_f32_16x16x32_bf16 v[108:111], v[32:35], a[128:131], v[108:111]
    s_waitcnt vmcnt(10)
    s_waitcnt lgkmcnt(2)
    v_mfma_f32_16x16x32_bf16 v[40:43], v[16:19], a[24:27], v[40:43]
    v_pk_add_u16 v32, v16, s66 op_sel:[1,0] op_sel_hi:[0,1]
    v_pk_add_u16 v33, v17, s66 op_sel:[1,0] op_sel_hi:[0,1]
    v_mfma_f32_16x16x32_bf16 v[48:51], v[16:19], a[60:63], v[48:51]
    v_pk_add_u16 v34, v18, s66 op_sel:[1,0] op_sel_hi:[0,1]
    v_pk_add_u16 v35, v19, s66 op_sel:[1,0] op_sel_hi:[0,1]
    v_mfma_f32_16x16x32_bf16 v[56:59], v[16:19], a[96:99], v[56:59]
    ds_read_b128 v[28:31], v5 offset:896
    v_mfma_f32_16x16x32_bf16 v[64:67], v[16:19], a[132:135], v[64:67]
    v_mfma_f32_16x16x32_bf16 v[72:75], v[16:19], a[168:171], v[72:75]
    v_mfma_f32_16x16x32_bf16 v[44:47], v[32:35], a[24:27], v[44:47]
    v_mfma_f32_16x16x32_bf16 v[52:55], v[32:35], a[60:63], v[52:55]
    v_mfma_f32_16x16x32_bf16 v[60:63], v[32:35], a[96:99], v[60:63]
    v_mfma_f32_16x16x32_bf16 v[68:71], v[32:35], a[132:135], v[68:71]
    v_mfma_f32_16x16x32_bf16 v[76:79], v[32:35], a[168:171], v[76:79]
    s_add_u32 m0, s39, 32768
    s_add_u32 s35, s38, 2097152
    s_lshr_b32 s3, s35, 8
    s_and_b32 s3, s3, 8192
    s_xor_b32 s35, s35, s3
    buffer_load_dwordx4 v2, s[12:15], s35 offen offset:0 sc1 lds
    buffer_load_dwordx4 v2, s[12:15], s35 offen offset:1024 sc1 lds
    buffer_load_dwordx4 v2, s[12:15], s35 offen offset:2048 sc1 lds
    buffer_load_dwordx4 v12, s[12:15], s35 offen offset:3072 sc1 lds
    s_waitcnt lgkmcnt(2)
    v_mfma_f32_16x16x32_bf16 v[80:83], v[20:23], a[24:27], v[80:83]
    v_pk_add_u16 v32, v20, s66 op_sel:[1,0] op_sel_hi:[0,1]
    v_pk_add_u16 v33, v21, s66 op_sel:[1,0] op_sel_hi:[0,1]
    v_mfma_f32_16x16x32_bf16 v[88:91], v[20:23], a[60:63], v[88:91]
    v_pk_add_u16 v34, v22, s66 op_sel:[1,0] op_sel_hi:[0,1]
    v_pk_add_u16 v35, v23, s66 op_sel:[1,0] op_sel_hi:[0,1]
    v_mfma_f32_16x16x32_bf16 v[96:99], v[20:23], a[96:99], v[96:99]
    ds_read_b128 v[16:19], v4 offset:1024
    v_mfma_f32_16x16x32_bf16 v[104:107], v[20:23], a[132:135], v[104:107]
    v_mfma_f32_16x16x32_bf16 v[84:87], v[32:35], a[24:27], v[84:87]
    v_mfma_f32_16x16x32_bf16 v[92:95], v[32:35], a[60:63], v[92:95]
    v_mfma_f32_16x16x32_bf16 v[100:103], v[32:35], a[96:99], v[100:103]
    v_mfma_f32_16x16x32_bf16 v[108:111], v[32:35], a[132:135], v[108:111]
    s_waitcnt vmcnt(9)
    s_waitcnt lgkmcnt(2)
    v_mfma_f32_16x16x32_bf16 v[40:43], v[24:27], a[28:31], v[40:43]
    v_pk_add_u16 v32, v24, s66 op_sel:[1,0] op_sel_hi:[0,1]
    v_pk_add_u16 v33, v25, s66 op_sel:[1,0] op_sel_hi:[0,1]
    v_mfma_f32_16x16x32_bf16 v[48:51], v[24:27], a[64:67], v[48:51]
    v_pk_add_u16 v34, v26, s66 op_sel:[1,0] op_sel_hi:[0,1]
    v_pk_add_u16 v35, v27, s66 op_sel:[1,0] op_sel_hi:[0,1]
    v_mfma_f32_16x16x32_bf16 v[56:59], v[24:27], a[100:103], v[56:59]
    ds_read_b128 v[20:23], v5 offset:1024
    v_mfma_f32_16x16x32_bf16 v[64:67], v[24:27], a[136:139], v[64:67]
    v_mfma_f32_16x16x32_bf16 v[72:75], v[24:27], a[172:175], v[72:75]
    v_mfma_f32_16x16x32_bf16 v[44:47], v[32:35], a[28:31], v[44:47]
    v_mfma_f32_16x16x32_bf16 v[52:55], v[32:35], a[64:67], v[52:55]
    v_mfma_f32_16x16x32_bf16 v[60:63], v[32:35], a[100:103], v[60:63]
    v_mfma_f32_16x16x32_bf16 v[68:71], v[32:35], a[136:139], v[68:71]
    v_mfma_f32_16x16x32_bf16 v[76:79], v[32:35], a[172:175], v[76:79]
    s_waitcnt lgkmcnt(2)
    v_mfma_f32_16x16x32_bf16 v[80:83], v[28:31], a[28:31], v[80:83]
    v_pk_add_u16 v32, v28, s66 op_sel:[1,0] op_sel_hi:[0,1]
    v_pk_add_u16 v33, v29, s66 op_sel:[1,0] op_sel_hi:[0,1]
    v_mfma_f32_16x16x32_bf16 v[88:91], v[28:31], a[64:67], v[88:91]
    v_pk_add_u16 v34, v30, s66 op_sel:[1,0] op_sel_hi:[0,1]
    v_pk_add_u16 v35, v31, s66 op_sel:[1,0] op_sel_hi:[0,1]
    v_mfma_f32_16x16x32_bf16 v[96:99], v[28:31], a[100:103], v[96:99]
    v_mfma_f32_16x16x32_bf16 v[104:107], v[28:31], a[136:139], v[104:107]
    v_mfma_f32_16x16x32_bf16 v[84:87], v[32:35], a[28:31], v[84:87]
    v_mfma_f32_16x16x32_bf16 v[92:95], v[32:35], a[64:67], v[92:95]
    v_mfma_f32_16x16x32_bf16 v[100:103], v[32:35], a[100:103], v[100:103]
    v_mfma_f32_16x16x32_bf16 v[108:111], v[32:35], a[136:139], v[108:111]
    s_waitcnt vmcnt(4)
    s_waitcnt lgkmcnt(1)
    v_mfma_f32_16x16x32_bf16 v[40:43], v[16:19], a[32:35], v[40:43]
    v_pk_add_u16 v32, v16, s66 op_sel:[1,0] op_sel_hi:[0,1]
    v_pk_add_u16 v33, v17, s66 op_sel:[1,0] op_sel_hi:[0,1]
    v_mfma_f32_16x16x32_bf16 v[48:51], v[16:19], a[68:71], v[48:51]
    v_pk_add_u16 v34, v18, s66 op_sel:[1,0] op_sel_hi:[0,1]
    v_pk_add_u16 v35, v19, s66 op_sel:[1,0] op_sel_hi:[0,1]
    v_mfma_f32_16x16x32_bf16 v[56:59], v[16:19], a[104:107], v[56:59]
    v_mfma_f32_16x16x32_bf16 v[64:67], v[16:19], a[140:143], v[64:67]
    v_mfma_f32_16x16x32_bf16 v[72:75], v[16:19], a[176:179], v[72:75]
    v_mfma_f32_16x16x32_bf16 v[44:47], v[32:35], a[32:35], v[44:47]
    v_mfma_f32_16x16x32_bf16 v[52:55], v[32:35], a[68:71], v[52:55]
    v_mfma_f32_16x16x32_bf16 v[60:63], v[32:35], a[104:107], v[60:63]
    v_mfma_f32_16x16x32_bf16 v[68:71], v[32:35], a[140:143], v[68:71]
    v_mfma_f32_16x16x32_bf16 v[76:79], v[32:35], a[176:179], v[76:79]
    s_waitcnt lgkmcnt(0)
    v_mfma_f32_16x16x32_bf16 v[80:83], v[20:23], a[32:35], v[80:83]
    v_pk_add_u16 v32, v20, s66 op_sel:[1,0] op_sel_hi:[0,1]
    v_pk_add_u16 v33, v21, s66 op_sel:[1,0] op_sel_hi:[0,1]
    v_mfma_f32_16x16x32_bf16 v[88:91], v[20:23], a[68:71], v[88:91]
    v_pk_add_u16 v34, v22, s66 op_sel:[1,0] op_sel_hi:[0,1]
    v_pk_add_u16 v35, v23, s66 op_sel:[1,0] op_sel_hi:[0,1]
    v_mfma_f32_16x16x32_bf16 v[96:99], v[20:23], a[104:107], v[96:99]
    v_mfma_f32_16x16x32_bf16 v[104:107], v[20:23], a[140:143], v[104:107]
    v_mfma_f32_16x16x32_bf16 v[84:87], v[32:35], a[32:35], v[84:87]
    v_mfma_f32_16x16x32_bf16 v[92:95], v[32:35], a[68:71], v[92:95]
    v_mfma_f32_16x16x32_bf16 v[100:103], v[32:35], a[104:107], v[100:103]
    v_mfma_f32_16x16x32_bf16 v[108:111], v[32:35], a[140:143], v[108:111]
    s_waitcnt vmcnt(0)
    s_barrier
    ds_read_b128 v[212:215], v4 offset:16384
    ds_read_b128 v[216:219], v4 offset:16512
    ds_read_b128 v[220:223], v4 offset:16640
    s_waitcnt lgkmcnt(0)
    v_mfma_f32_16x16x32_bf16 v[112:115], v[212:215], a[0:3], 0
    v_pk_add_u16 v16, v212, s66 op_sel:[1,0] op_sel_hi:[0,1]
    v_mfma_f32_16x16x32_bf16 v[112:115], v[216:219], a[4:7], v[112:115]
    v_pk_add_u16 v17, v213, s66 op_sel:[1,0] op_sel_hi:[0,1]
    v_mfma_f32_16x16x32_bf16 v[112:115], v[220:223], a[8:11], v[112:115]
    v_pk_add_u16 v18, v214, s66 op_sel:[1,0] op_sel_hi:[0,1]
    v_pk_add_u16 v19, v215, s66 op_sel:[1,0] op_sel_hi:[0,1]
    v_mfma_f32_16x16x32_bf16 v[120:123], v[212:215], a[36:39], 0
    v_pk_add_u16 v20, v216, s66 op_sel:[1,0] op_sel_hi:[0,1]
    v_mfma_f32_16x16x32_bf16 v[120:123], v[216:219], a[40:43], v[120:123]
    v_pk_add_u16 v21, v217, s66 op_sel:[1,0] op_sel_hi:[0,1]
    v_mfma_f32_16x16x32_bf16 v[120:123], v[220:223], a[44:47], v[120:123]
    v_pk_add_u16 v22, v218, s66 op_sel:[1,0] op_sel_hi:[0,1]
    v_pk_add_u16 v23, v219, s66 op_sel:[1,0] op_sel_hi:[0,1]
    v_mfma_f32_16x16x32_bf16 v[128:131], v[212:215], a[72:75], 0
    v_pk_add_u16 v24, v220, s66 op_sel:[1,0] op_sel_hi:[0,1]
    v_mfma_f32_16x16x32_bf16 v[128:131], v[216:219], a[76:79], v[128:131]
    v_pk_add_u16 v25, v221, s66 op_sel:[1,0] op_sel_hi:[0,1]
    v_cvt_pk_bf16_f32 v180, v80, v84
    v_mfma_f32_16x16x32_bf16 v[128:131], v[220:223], a[80:83], v[128:131]
    v_pk_add_u16 v26, v222, s66 op_sel:[1,0] op_sel_hi:[0,1]
    v_pk_add_u16 v27, v223, s66 op_sel:[1,0] op_sel_hi:[0,1]
    v_mfma_f32_16x16x32_bf16 v[136:139], v[212:215], a[108:111], 0
    v_cvt_pk_bf16_f32 v181, v81, v85
    v_cvt_pk_bf16_f32 v182, v82, v86
    v_mfma_f32_16x16x32_bf16 v[136:139], v[216:219], a[112:115], v[136:139]
    v_cvt_pk_bf16_f32 v183, v83, v87
    v_mfma_f32_16x16x32_bf16 v[136:139], v[220:223], a[116:119], v[136:139]
    v_cvt_pk_bf16_f32 v184, v88, v92
    v_cvt_pk_bf16_f32 v185, v89, v93
    v_mfma_f32_16x16x32_bf16 v[144:147], v[212:215], a[144:147], 0
    v_cvt_pk_bf16_f32 v186, v90, v94
    v_mfma_f32_16x16x32_bf16 v[144:147], v[216:219], a[148:151], v[144:147]
    v_cvt_pk_bf16_f32 v187, v91, v95
    v_permlane16_swap_b32 v180, v184
    v_mfma_f32_16x16x32_bf16 v[144:147], v[220:223], a[152:155], v[144:147]
    v_permlane16_swap_b32 v181, v185
    v_mfma_f32_16x16x32_bf16 v[116:119], v[16:19], a[0:3], 0
    ds_read_b128 v[224:227], v4 offset:16768
    v_permlane16_swap_b32 v182, v186
    v_mfma_f32_16x16x32_bf16 v[116:119], v[20:23], a[4:7], v[116:119]
    ds_read_b128 v[228:231], v4 offset:16896
    v_permlane16_swap_b32 v183, v187
    v_mfma_f32_16x16x32_bf16 v[116:119], v[24:27], a[8:11], v[116:119]
    ds_read_b128 v[232:235], v4 offset:17024
    buffer_store_dword v180, v7, s[12:15], 0 offen sc1
    v_mfma_f32_16x16x32_bf16 v[124:127], v[16:19], a[36:39], 0
    buffer_store_dword v184, v7, s[12:15], s44 offen sc1
    v_mfma_f32_16x16x32_bf16 v[124:127], v[20:23], a[40:43], v[124:127]
    v_cvt_pk_bf16_f32 v188, v96, v100
    v_cvt_pk_bf16_f32 v189, v97, v101
    v_mfma_f32_16x16x32_bf16 v[124:127], v[24:27], a[44:47], v[124:127]
    v_cvt_pk_bf16_f32 v190, v98, v102
    v_mfma_f32_16x16x32_bf16 v[132:135], v[16:19], a[72:75], 0
    v_cvt_pk_bf16_f32 v191, v99, v103
    v_cvt_pk_bf16_f32 v192, v104, v108
    v_mfma_f32_16x16x32_bf16 v[132:135], v[20:23], a[76:79], v[132:135]
    v_cvt_pk_bf16_f32 v193, v105, v109
    v_mfma_f32_16x16x32_bf16 v[132:135], v[24:27], a[80:83], v[132:135]
    buffer_store_dword v181, v7, s[12:15], s41 offen sc1
    v_cvt_pk_bf16_f32 v194, v106, v110
    v_mfma_f32_16x16x32_bf16 v[140:143], v[16:19], a[108:111], 0
    v_cvt_pk_bf16_f32 v195, v107, v111
    v_mfma_f32_16x16x32_bf16 v[140:143], v[20:23], a[112:115], v[140:143]
    v_permlane16_swap_b32 v188, v192
    v_permlane16_swap_b32 v189, v193
    v_mfma_f32_16x16x32_bf16 v[140:143], v[24:27], a[116:119], v[140:143]
    v_permlane16_swap_b32 v190, v194
    v_mfma_f32_16x16x32_bf16 v[148:151], v[16:19], a[144:147], 0
    v_permlane16_swap_b32 v191, v195
    v_cvt_pk_bf16_f32 v160, v40, v44
    v_mfma_f32_16x16x32_bf16 v[148:151], v[20:23], a[148:151], v[148:151]
    buffer_store_dword v185, v7, s[12:15], s45 offen sc1
    v_mfma_f32_16x16x32_bf16 v[148:151], v[24:27], a[152:155], v[148:151]
    v_cvt_pk_bf16_f32 v161, v41, v45
    v_cvt_pk_bf16_f32 v162, v42, v46
    s_waitcnt lgkmcnt(0)
    v_mfma_f32_16x16x32_bf16 v[112:115], v[224:227], a[12:15], v[112:115]
    v_pk_add_u16 v16, v224, s66 op_sel:[1,0] op_sel_hi:[0,1]
    v_cvt_pk_bf16_f32 v163, v43, v47
    v_mfma_f32_16x16x32_bf16 v[112:115], v[228:231], a[16:19], v[112:115]
    v_pk_add_u16 v17, v225, s66 op_sel:[1,0] op_sel_hi:[0,1]
    v_cvt_pk_bf16_f32 v164, v48, v52
    v_mfma_f32_16x16x32_bf16 v[112:115], v[232:235], a[20:23], v[112:115]
    v_pk_add_u16 v18, v226, s66 op_sel:[1,0] op_sel_hi:[0,1]
    v_pk_add_u16 v19, v227, s66 op_sel:[1,0] op_sel_hi:[0,1]
    v_mfma_f32_16x16x32_bf16 v[120:123], v[224:227], a[48:51], v[120:123]
    v_pk_add_u16 v20, v228, s66 op_sel:[1,0] op_sel_hi:[0,1]
    buffer_store_dword v182, v7, s[12:15], s42 offen sc1
    v_mfma_f32_16x16x32_bf16 v[120:123], v[228:231], a[52:55], v[120:123]
    v_pk_add_u16 v21, v229, s66 op_sel:[1,0] op_sel_hi:[0,1]
    v_cvt_pk_bf16_f32 v165, v49, v53
    v_mfma_f32_16x16x32_bf16 v[120:123], v[232:235], a[56:59], v[120:123]
    v_pk_add_u16 v22, v230, s66 op_sel:[1,0] op_sel_hi:[0,1]
    v_pk_add_u16 v23, v231, s66 op_sel:[1,0] op_sel_hi:[0,1]
    v_mfma_f32_16x16x32_bf16 v[128:131], v[224:227], a[84:87], v[128:131]
    v_pk_add_u16 v24, v232, s66 op_sel:[1,0] op_sel_hi:[0,1]
    v_cvt_pk_bf16_f32 v166, v50, v54
    v_mfma_f32_16x16x32_bf16 v[128:131], v[228:231], a[88:91], v[128:131]
    v_pk_add_u16 v25, v233, s66 op_sel:[1,0] op_sel_hi:[0,1]
    buffer_store_dword v186, v7, s[12:15], s46 offen sc1
    v_mfma_f32_16x16x32_bf16 v[128:131], v[232:235], a[92:95], v[128:131]
    v_pk_add_u16 v26, v234, s66 op_sel:[1,0] op_sel_hi:[0,1]
    v_pk_add_u16 v27, v235, s66 op_sel:[1,0] op_sel_hi:[0,1]
    v_mfma_f32_16x16x32_bf16 v[136:139], v[224:227], a[120:123], v[136:139]
    v_cvt_pk_bf16_f32 v167, v51, v55
    v_permlane16_swap_b32 v160, v164
    v_mfma_f32_16x16x32_bf16 v[136:139], v[228:231], a[124:127], v[136:139]
    v_permlane16_swap_b32 v161, v165
    v_mfma_f32_16x16x32_bf16 v[136:139], v[232:235], a[128:131], v[136:139]
    v_permlane16_swap_b32 v162, v166
    v_permlane16_swap_b32 v163, v167
    v_mfma_f32_16x16x32_bf16 v[144:147], v[224:227], a[156:159], v[144:147]
    buffer_store_dword v183, v7, s[12:15], s43 offen sc1
    v_mfma_f32_16x16x32_bf16 v[144:147], v[228:231], a[160:163], v[144:147]
    v_cvt_pk_bf16_f32 v168, v56, v60
    v_cvt_pk_bf16_f32 v169, v57, v61
    v_mfma_f32_16x16x32_bf16 v[144:147], v[232:235], a[164:167], v[144:147]
    v_cvt_pk_bf16_f32 v170, v58, v62
    v_mfma_f32_16x16x32_bf16 v[116:119], v[16:19], a[12:15], v[116:119]
    ds_read_b128 v[212:215], v4 offset:17152
    v_cvt_pk_bf16_f32 v171, v59, v63
    v_mfma_f32_16x16x32_bf16 v[116:119], v[20:23], a[16:19], v[116:119]
    ds_read_b128 v[216:219], v4 offset:17280
    v_cvt_pk_bf16_f32 v172, v64, v68
    v_mfma_f32_16x16x32_bf16 v[116:119], v[24:27], a[20:23], v[116:119]
    ds_read_b128 v[220:223], v4 offset:17408
    buffer_store_dword v188, v7, s[12:15], s47 offen sc1
    v_mfma_f32_16x16x32_bf16 v[124:127], v[16:19], a[48:51], v[124:127]
    v_cvt_pk_bf16_f32 v173, v65, v69
    v_mfma_f32_16x16x32_bf16 v[124:127], v[20:23], a[52:55], v[124:127]
    v_cvt_pk_bf16_f32 v174, v66, v70
    v_cvt_pk_bf16_f32 v175, v67, v71
    v_mfma_f32_16x16x32_bf16 v[124:127], v[24:27], a[56:59], v[124:127]
    v_permlane16_swap_b32 v168, v172
    v_mfma_f32_16x16x32_bf16 v[132:135], v[16:19], a[84:87], v[132:135]
    buffer_store_dword v192, v7, s[12:15], s51 offen sc1
    v_permlane16_swap_b32 v169, v173
    v_mfma_f32_16x16x32_bf16 v[132:135], v[20:23], a[88:91], v[132:135]
    v_permlane16_swap_b32 v170, v174
    v_mfma_f32_16x16x32_bf16 v[132:135], v[24:27], a[92:95], v[132:135]
    v_permlane16_swap_b32 v171, v175
    v_cvt_pk_bf16_f32 v176, v72, v76
    v_mfma_f32_16x16x32_bf16 v[140:143], v[16:19], a[120:123], v[140:143]
    v_cvt_pk_bf16_f32 v177, v73, v77
    v_mfma_f32_16x16x32_bf16 v[140:143], v[20:23], a[124:127], v[140:143]
    v_cvt_pk_bf16_f32 v178, v74, v78
    v_cvt_pk_bf16_f32 v179, v75, v79
    v_mfma_f32_16x16x32_bf16 v[140:143], v[24:27], a[128:131], v[140:143]
    buffer_store_dword v189, v7, s[12:15], s48 offen sc1
    v_mfma_f32_16x16x32_bf16 v[148:151], v[16:19], a[156:159], v[148:151]
    v_mfma_f32_16x16x32_bf16 v[148:151], v[20:23], a[160:163], v[148:151]
    v_mfma_f32_16x16x32_bf16 v[148:151], v[24:27], a[164:167], v[148:151]
    s_waitcnt lgkmcnt(0)
    v_mfma_f32_16x16x32_bf16 v[112:115], v[212:215], a[24:27], v[112:115]
    v_pk_add_u16 v16, v212, s66 op_sel:[1,0] op_sel_hi:[0,1]
    v_mfma_f32_16x16x32_bf16 v[112:115], v[216:219], a[28:31], v[112:115]
    v_pk_add_u16 v17, v213, s66 op_sel:[1,0] op_sel_hi:[0,1]
    buffer_store_dword v193, v7, s[12:15], s30 offen sc1
    v_mfma_f32_16x16x32_bf16 v[112:115], v[220:223], a[32:35], v[112:115]
    v_pk_add_u16 v18, v214, s66 op_sel:[1,0] op_sel_hi:[0,1]
    v_pk_add_u16 v19, v215, s66 op_sel:[1,0] op_sel_hi:[0,1]
    v_mfma_f32_16x16x32_bf16 v[120:123], v[212:215], a[60:63], v[120:123]
    v_pk_add_u16 v20, v216, s66 op_sel:[1,0] op_sel_hi:[0,1]
    v_mfma_f32_16x16x32_bf16 v[120:123], v[216:219], a[64:67], v[120:123]
    v_pk_add_u16 v21, v217, s66 op_sel:[1,0] op_sel_hi:[0,1]
    v_mfma_f32_16x16x32_bf16 v[120:123], v[220:223], a[68:71], v[120:123]
    v_pk_add_u16 v22, v218, s66 op_sel:[1,0] op_sel_hi:[0,1]
    v_pk_add_u16 v23, v219, s66 op_sel:[1,0] op_sel_hi:[0,1]
    v_mfma_f32_16x16x32_bf16 v[128:131], v[212:215], a[96:99], v[128:131]
    v_pk_add_u16 v24, v220, s66 op_sel:[1,0] op_sel_hi:[0,1]
    buffer_store_dword v190, v7, s[12:15], s49 offen sc1
    v_mfma_f32_16x16x32_bf16 v[128:131], v[216:219], a[100:103], v[128:131]
    v_pk_add_u16 v25, v221, s66 op_sel:[1,0] op_sel_hi:[0,1]
    v_mfma_f32_16x16x32_bf16 v[128:131], v[220:223], a[104:107], v[128:131]
    v_pk_add_u16 v26, v222, s66 op_sel:[1,0] op_sel_hi:[0,1]
    v_pk_add_u16 v27, v223, s66 op_sel:[1,0] op_sel_hi:[0,1]
    v_mfma_f32_16x16x32_bf16 v[136:139], v[212:215], a[132:135], v[136:139]
    v_mfma_f32_16x16x32_bf16 v[136:139], v[216:219], a[136:139], v[136:139]
    buffer_store_dword v194, v7, s[12:15], s31 offen sc1
    v_mfma_f32_16x16x32_bf16 v[136:139], v[220:223], a[140:143], v[136:139]
    v_mfma_f32_16x16x32_bf16 v[144:147], v[212:215], a[168:171], v[144:147]
    v_mfma_f32_16x16x32_bf16 v[144:147], v[216:219], a[172:175], v[144:147]
    v_mfma_f32_16x16x32_bf16 v[144:147], v[220:223], a[176:179], v[144:147]
    v_mfma_f32_16x16x32_bf16 v[116:119], v[16:19], a[24:27], v[116:119]
    ds_read_b128 v[224:227], v5 offset:16384
    buffer_store_dword v191, v7, s[12:15], s50 offen sc1
    v_add_u32 v7, 4194304, v7
    v_mfma_f32_16x16x32_bf16 v[116:119], v[20:23], a[28:31], v[116:119]
    ds_read_b128 v[228:231], v5 offset:16512
    v_mfma_f32_16x16x32_bf16 v[116:119], v[24:27], a[32:35], v[116:119]
    ds_read_b128 v[232:235], v5 offset:16640
    v_mfma_f32_16x16x32_bf16 v[124:127], v[16:19], a[60:63], v[124:127]
    v_mfma_f32_16x16x32_bf16 v[124:127], v[20:23], a[64:67], v[124:127]
    v_mfma_f32_16x16x32_bf16 v[124:127], v[24:27], a[68:71], v[124:127]
    buffer_store_dword v160, v6, s[12:15], 0 offen sc1
    v_mfma_f32_16x16x32_bf16 v[132:135], v[16:19], a[96:99], v[132:135]
    v_mfma_f32_16x16x32_bf16 v[132:135], v[20:23], a[100:103], v[132:135]
    v_mfma_f32_16x16x32_bf16 v[132:135], v[24:27], a[104:107], v[132:135]
    v_mfma_f32_16x16x32_bf16 v[140:143], v[16:19], a[132:135], v[140:143]
    v_mfma_f32_16x16x32_bf16 v[140:143], v[20:23], a[136:139], v[140:143]
    buffer_store_dword v164, v6, s[12:15], s44 offen sc1
    v_mfma_f32_16x16x32_bf16 v[140:143], v[24:27], a[140:143], v[140:143]
    v_mfma_f32_16x16x32_bf16 v[148:151], v[16:19], a[168:171], v[148:151]
    v_mfma_f32_16x16x32_bf16 v[148:151], v[20:23], a[172:175], v[148:151]
    v_mfma_f32_16x16x32_bf16 v[148:151], v[24:27], a[176:179], v[148:151]
    buffer_store_dword v161, v6, s[12:15], s41 offen sc1
    s_waitcnt lgkmcnt(0)
    v_mfma_f32_16x16x32_bf16 v[80:83], v[224:227], a[0:3], 0
    v_pk_add_u16 v16, v224, s66 op_sel:[1,0] op_sel_hi:[0,1]
    v_pk_add_u16 v17, v225, s66 op_sel:[1,0] op_sel_hi:[0,1]
    v_mfma_f32_16x16x32_bf16 v[80:83], v[228:231], a[4:7], v[80:83]
    v_pk_add_u16 v18, v226, s66 op_sel:[1,0] op_sel_hi:[0,1]
    v_pk_add_u16 v19, v227, s66 op_sel:[1,0] op_sel_hi:[0,1]
    v_mfma_f32_16x16x32_bf16 v[80:83], v[232:235], a[8:11], v[80:83]
    v_pk_add_u16 v20, v228, s66 op_sel:[1,0] op_sel_hi:[0,1]
    v_pk_add_u16 v21, v229, s66 op_sel:[1,0] op_sel_hi:[0,1]
    v_mfma_f32_16x16x32_bf16 v[88:91], v[224:227], a[36:39], 0
    v_pk_add_u16 v22, v230, s66 op_sel:[1,0] op_sel_hi:[0,1]
    v_mfma_f32_16x16x32_bf16 v[88:91], v[228:231], a[40:43], v[88:91]
    v_pk_add_u16 v23, v231, s66 op_sel:[1,0] op_sel_hi:[0,1]
    v_mfma_f32_16x16x32_bf16 v[88:91], v[232:235], a[44:47], v[88:91]
    v_pk_add_u16 v24, v232, s66 op_sel:[1,0] op_sel_hi:[0,1]
    v_pk_add_u16 v25, v233, s66 op_sel:[1,0] op_sel_hi:[0,1]
    v_mfma_f32_16x16x32_bf16 v[96:99], v[224:227], a[72:75], 0
    v_pk_add_u16 v26, v234, s66 op_sel:[1,0] op_sel_hi:[0,1]
    buffer_store_dword v165, v6, s[12:15], s45 offen sc1
    v_mfma_f32_16x16x32_bf16 v[96:99], v[228:231], a[76:79], v[96:99]
    v_pk_add_u16 v27, v235, s66 op_sel:[1,0] op_sel_hi:[0,1]
    v_cvt_pk_bf16_f32 v112, v112, v116
    v_mfma_f32_16x16x32_bf16 v[96:99], v[232:235], a[80:83], v[96:99]
    v_cvt_pk_bf16_f32 v113, v113, v117
    v_mfma_f32_16x16x32_bf16 v[104:107], v[224:227], a[108:111], 0
    v_cvt_pk_bf16_f32 v114, v114, v118
    v_cvt_pk_bf16_f32 v115, v115, v119
    v_mfma_f32_16x16x32_bf16 v[104:107], v[228:231], a[112:115], v[104:107]
    buffer_store_dword v162, v6, s[12:15], s42 offen sc1
    v_mfma_f32_16x16x32_bf16 v[104:107], v[232:235], a[116:119], v[104:107]
    v_cvt_pk_bf16_f32 v120, v120, v124
    v_cvt_pk_bf16_f32 v121, v121, v125
    v_mfma_f32_16x16x32_bf16 v[84:87], v[16:19], a[0:3], 0
    ds_read_b128 v[212:215], v5 offset:16768
    v_cvt_pk_bf16_f32 v122, v122, v126
    v_mfma_f32_16x16x32_bf16 v[84:87], v[20:23], a[4:7], v[84:87]
    ds_read_b128 v[216:219], v5 offset:16896
    v_cvt_pk_bf16_f32 v123, v123, v127
    v_mfma_f32_16x16x32_bf16 v[84:87], v[24:27], a[8:11], v[84:87]
    ds_read_b128 v[220:223], v5 offset:17024
    v_permlane16_swap_b32 v112, v120
    v_mfma_f32_16x16x32_bf16 v[92:95], v[16:19], a[36:39], 0
    buffer_store_dword v166, v6, s[12:15], s46 offen sc1
    v_permlane16_swap_b32 v113, v121
    v_mfma_f32_16x16x32_bf16 v[92:95], v[20:23], a[40:43], v[92:95]
    v_permlane16_swap_b32 v114, v122
    v_mfma_f32_16x16x32_bf16 v[92:95], v[24:27], a[44:47], v[92:95]
    v_permlane16_swap_b32 v115, v123
    v_cvt_pk_bf16_f32 v128, v128, v132
    v_mfma_f32_16x16x32_bf16 v[100:103], v[16:19], a[72:75], 0
    v_cvt_pk_bf16_f32 v129, v129, v133
    v_mfma_f32_16x16x32_bf16 v[100:103], v[20:23], a[76:79], v[100:103]
    v_cvt_pk_bf16_f32 v130, v130, v134
    v_cvt_pk_bf16_f32 v131, v131, v135
    v_mfma_f32_16x16x32_bf16 v[100:103], v[24:27], a[80:83], v[100:103]
    buffer_store_dword v163, v6, s[12:15], s43 offen sc1
    v_mfma_f32_16x16x32_bf16 v[108:111], v[16:19], a[108:111], 0
    v_cvt_pk_bf16_f32 v136, v136, v140
    v_cvt_pk_bf16_f32 v137, v137, v141
    v_mfma_f32_16x16x32_bf16 v[108:111], v[20:23], a[112:115], v[108:111]
    v_cvt_pk_bf16_f32 v138, v138, v142
    v_mfma_f32_16x16x32_bf16 v[108:111], v[24:27], a[116:119], v[108:111]
    v_cvt_pk_bf16_f32 v139, v139, v143
    v_permlane16_swap_b32 v128, v136
    s_waitcnt lgkmcnt(0)
    v_mfma_f32_16x16x32_bf16 v[80:83], v[212:215], a[12:15], v[80:83]
    v_pk_add_u16 v16, v212, s66 op_sel:[1,0] op_sel_hi:[0,1]
    v_pk_add_u16 v17, v213, s66 op_sel:[1,0] op_sel_hi:[0,1]
    v_mfma_f32_16x16x32_bf16 v[80:83], v[216:219], a[16:19], v[80:83]
    v_pk_add_u16 v18, v214, s66 op_sel:[1,0] op_sel_hi:[0,1]
    v_pk_add_u16 v19, v215, s66 op_sel:[1,0] op_sel_hi:[0,1]
    v_mfma_f32_16x16x32_bf16 v[80:83], v[220:223], a[20:23], v[80:83]
    v_pk_add_u16 v20, v216, s66 op_sel:[1,0] op_sel_hi:[0,1]
    v_pk_add_u16 v21, v217, s66 op_sel:[1,0] op_sel_hi:[0,1]
    v_mfma_f32_16x16x32_bf16 v[88:91], v[212:215], a[48:51], v[88:91]
    v_pk_add_u16 v22, v218, s66 op_sel:[1,0] op_sel_hi:[0,1]
    buffer_store_dword v168, v6, s[12:15], s47 offen sc1
    v_mfma_f32_16x16x32_bf16 v[88:91], v[216:219], a[52:55], v[88:91]
    v_pk_add_u16 v23, v219, s66 op_sel:[1,0] op_sel_hi:[0,1]
    v_permlane16_swap_b32 v129, v137
    v_mfma_f32_16x16x32_bf16 v[88:91], v[220:223], a[56:59], v[88:91]
    v_pk_add_u16 v24, v220, s66 op_sel:[1,0] op_sel_hi:[0,1]
    v_pk_add_u16 v25, v221, s66 op_sel:[1,0] op_sel_hi:[0,1]
    v_mfma_f32_16x16x32_bf16 v[96:99], v[212:215], a[84:87], v[96:99]
    v_pk_add_u16 v26, v222, s66 op_sel:[1,0] op_sel_hi:[0,1]
    v_permlane16_swap_b32 v130, v138
    v_mfma_f32_16x16x32_bf16 v[96:99], v[216:219], a[88:91], v[96:99]
    v_pk_add_u16 v27, v223, s66 op_sel:[1,0] op_sel_hi:[0,1]
    buffer_store_dword v172, v6, s[12:15], s51 offen sc1
    v_mfma_f32_16x16x32_bf16 v[96:99], v[220:223], a[92:95], v[96:99]
    v_permlane16_swap_b32 v131, v139
    v_mfma_f32_16x16x32_bf16 v[104:107], v[212:215], a[120:123], v[104:107]
    v_cvt_pk_bf16_f32 v144, v144, v148
    v_cvt_pk_bf16_f32 v145, v145, v149
    v_mfma_f32_16x16x32_bf16 v[104:107], v[216:219], a[124:127], v[104:107]
    v_cvt_pk_bf16_f32 v146, v146, v150
    v_mfma_f32_16x16x32_bf16 v[104:107], v[220:223], a[128:131], v[104:107]
    v_cvt_pk_bf16_f32 v147, v147, v151
    v_mfma_f32_16x16x32_bf16 v[84:87], v[16:19], a[12:15], v[84:87]
    ds_read_b128 v[224:227], v5 offset:17152
    buffer_store_dword v169, v6, s[12:15], s48 offen sc1
    v_mfma_f32_16x16x32_bf16 v[84:87], v[20:23], a[16:19], v[84:87]
    ds_read_b128 v[228:231], v5 offset:17280
    v_mfma_f32_16x16x32_bf16 v[84:87], v[24:27], a[20:23], v[84:87]
    ds_read_b128 v[232:235], v5 offset:17408
    v_mfma_f32_16x16x32_bf16 v[92:95], v[16:19], a[48:51], v[92:95]
    v_mfma_f32_16x16x32_bf16 v[92:95], v[20:23], a[52:55], v[92:95]
    v_mfma_f32_16x16x32_bf16 v[92:95], v[24:27], a[56:59], v[92:95]
    v_mfma_f32_16x16x32_bf16 v[100:103], v[16:19], a[84:87], v[100:103]
    buffer_store_dword v173, v6, s[12:15], s30 offen sc1
    v_mfma_f32_16x16x32_bf16 v[100:103], v[20:23], a[88:91], v[100:103]
    v_mfma_f32_16x16x32_bf16 v[100:103], v[24:27], a[92:95], v[100:103]
    v_mfma_f32_16x16x32_bf16 v[108:111], v[16:19], a[120:123], v[108:111]
    v_mfma_f32_16x16x32_bf16 v[108:111], v[20:23], a[124:127], v[108:111]
    v_mfma_f32_16x16x32_bf16 v[108:111], v[24:27], a[128:131], v[108:111]
    buffer_store_dword v170, v6, s[12:15], s49 offen sc1
    s_waitcnt lgkmcnt(0)
    v_mfma_f32_16x16x32_bf16 v[80:83], v[224:227], a[24:27], v[80:83]
    v_pk_add_u16 v16, v224, s66 op_sel:[1,0] op_sel_hi:[0,1]
    v_pk_add_u16 v17, v225, s66 op_sel:[1,0] op_sel_hi:[0,1]
    v_mfma_f32_16x16x32_bf16 v[80:83], v[228:231], a[28:31], v[80:83]
    v_pk_add_u16 v18, v226, s66 op_sel:[1,0] op_sel_hi:[0,1]
    v_pk_add_u16 v19, v227, s66 op_sel:[1,0] op_sel_hi:[0,1]
    v_mfma_f32_16x16x32_bf16 v[80:83], v[232:235], a[32:35], v[80:83]
    v_pk_add_u16 v20, v228, s66 op_sel:[1,0] op_sel_hi:[0,1]
    v_pk_add_u16 v21, v229, s66 op_sel:[1,0] op_sel_hi:[0,1]
    v_mfma_f32_16x16x32_bf16 v[88:91], v[224:227], a[60:63], v[88:91]
    v_pk_add_u16 v22, v230, s66 op_sel:[1,0] op_sel_hi:[0,1]
    v_mfma_f32_16x16x32_bf16 v[88:91], v[228:231], a[64:67], v[88:91]
    v_pk_add_u16 v23, v231, s66 op_sel:[1,0] op_sel_hi:[0,1]
    buffer_store_dword v174, v6, s[12:15], s31 offen sc1
    v_mfma_f32_16x16x32_bf16 v[88:91], v[232:235], a[68:71], v[88:91]
    v_pk_add_u16 v24, v232, s66 op_sel:[1,0] op_sel_hi:[0,1]
    v_pk_add_u16 v25, v233, s66 op_sel:[1,0] op_sel_hi:[0,1]
    v_mfma_f32_16x16x32_bf16 v[96:99], v[224:227], a[96:99], v[96:99]
    v_pk_add_u16 v26, v234, s66 op_sel:[1,0] op_sel_hi:[0,1]
    v_mfma_f32_16x16x32_bf16 v[96:99], v[228:231], a[100:103], v[96:99]
    v_pk_add_u16 v27, v235, s66 op_sel:[1,0] op_sel_hi:[0,1]
    v_mfma_f32_16x16x32_bf16 v[96:99], v[232:235], a[104:107], v[96:99]
    v_mfma_f32_16x16x32_bf16 v[104:107], v[224:227], a[132:135], v[104:107]
    buffer_store_dword v171, v6, s[12:15], s50 offen sc1
    v_add_u32 v6, 4194304, v6
    v_mfma_f32_16x16x32_bf16 v[104:107], v[228:231], a[136:139], v[104:107]
    v_mfma_f32_16x16x32_bf16 v[104:107], v[232:235], a[140:143], v[104:107]
    v_mfma_f32_16x16x32_bf16 v[84:87], v[16:19], a[24:27], v[84:87]
    ds_read_b128 v[212:215], v4 offset:32768
    v_mfma_f32_16x16x32_bf16 v[84:87], v[20:23], a[28:31], v[84:87]
    ds_read_b128 v[216:219], v4 offset:32896
    v_mfma_f32_16x16x32_bf16 v[84:87], v[24:27], a[32:35], v[84:87]
    ds_read_b128 v[220:223], v4 offset:33024
    v_mfma_f32_16x16x32_bf16 v[92:95], v[16:19], a[60:63], v[92:95]
    buffer_store_dword v176, v8, s[12:15], 0 offen sc1
    v_mfma_f32_16x16x32_bf16 v[92:95], v[20:23], a[64:67], v[92:95]
    v_mfma_f32_16x16x32_bf16 v[92:95], v[24:27], a[68:71], v[92:95]
    v_mfma_f32_16x16x32_bf16 v[100:103], v[16:19], a[96:99], v[100:103]
    v_mfma_f32_16x16x32_bf16 v[100:103], v[20:23], a[100:103], v[100:103]
    v_mfma_f32_16x16x32_bf16 v[100:103], v[24:27], a[104:107], v[100:103]
    buffer_store_dword v177, v8, s[12:15], s41 offen sc1
    v_mfma_f32_16x16x32_bf16 v[108:111], v[16:19], a[132:135], v[108:111]
    v_mfma_f32_16x16x32_bf16 v[108:111], v[20:23], a[136:139], v[108:111]
    v_mfma_f32_16x16x32_bf16 v[108:111], v[24:27], a[140:143], v[108:111]
    s_waitcnt lgkmcnt(0)
    v_mfma_f32_16x16x32_bf16 v[40:43], v[212:215], a[0:3], 0
    v_pk_add_u16 v16, v212, s66 op_sel:[1,0] op_sel_hi:[0,1]
    buffer_store_dword v178, v8, s[12:15], s42 offen sc1
    v_mfma_f32_16x16x32_bf16 v[40:43], v[216:219], a[4:7], v[40:43]
    v_pk_add_u16 v17, v213, s66 op_sel:[1,0] op_sel_hi:[0,1]
    v_mfma_f32_16x16x32_bf16 v[40:43], v[220:223], a[8:11], v[40:43]
    v_pk_add_u16 v18, v214, s66 op_sel:[1,0] op_sel_hi:[0,1]
    v_pk_add_u16 v19, v215, s66 op_sel:[1,0] op_sel_hi:[0,1]
    v_mfma_f32_16x16x32_bf16 v[48:51], v[212:215], a[36:39], 0
    v_pk_add_u16 v20, v216, s66 op_sel:[1,0] op_sel_hi:[0,1]
    buffer_store_dword v179, v9, s[12:15], s43 offen sc1
    v_add_u32 v8, 4194304, v8
    v_add_u32 v9, 4194304, v9
    v_mfma_f32_16x16x32_bf16 v[48:51], v[216:219], a[40:43], v[48:51]
    v_pk_add_u16 v21, v217, s66 op_sel:[1,0] op_sel_hi:[0,1]
    v_mfma_f32_16x16x32_bf16 v[48:51], v[220:223], a[44:47], v[48:51]
    v_pk_add_u16 v22, v218, s66 op_sel:[1,0] op_sel_hi:[0,1]
    v_pk_add_u16 v23, v219, s66 op_sel:[1,0] op_sel_hi:[0,1]
    v_mfma_f32_16x16x32_bf16 v[56:59], v[212:215], a[72:75], 0
    v_pk_add_u16 v24, v220, s66 op_sel:[1,0] op_sel_hi:[0,1]
    buffer_store_dword v112, v6, s[12:15], 0 offen sc1
    v_mfma_f32_16x16x32_bf16 v[56:59], v[216:219], a[76:79], v[56:59]
    v_pk_add_u16 v25, v221, s66 op_sel:[1,0] op_sel_hi:[0,1]
    buffer_store_dword v120, v6, s[12:15], s44 offen sc1
    v_mfma_f32_16x16x32_bf16 v[56:59], v[220:223], a[80:83], v[56:59]
    v_pk_add_u16 v26, v222, s66 op_sel:[1,0] op_sel_hi:[0,1]
    v_pk_add_u16 v27, v223, s66 op_sel:[1,0] op_sel_hi:[0,1]
    v_mfma_f32_16x16x32_bf16 v[64:67], v[212:215], a[108:111], 0
    v_cvt_pk_bf16_f32 v196, v80, v84
    v_cvt_pk_bf16_f32 v197, v81, v85
    v_mfma_f32_16x16x32_bf16 v[64:67], v[216:219], a[112:115], v[64:67]
    buffer_store_dword v113, v6, s[12:15], s41 offen sc1
    v_mfma_f32_16x16x32_bf16 v[64:67], v[220:223], a[116:119], v[64:67]
    v_cvt_pk_bf16_f32 v198, v82, v86
    v_cvt_pk_bf16_f32 v199, v83, v87
    v_mfma_f32_16x16x32_bf16 v[72:75], v[212:215], a[144:147], 0
    buffer_store_dword v121, v6, s[12:15], s45 offen sc1
    v_mfma_f32_16x16x32_bf16 v[72:75], v[216:219], a[148:151], v[72:75]
    v_cvt_pk_bf16_f32 v200, v88, v92
    v_cvt_pk_bf16_f32 v201, v89, v93
    v_mfma_f32_16x16x32_bf16 v[72:75], v[220:223], a[152:155], v[72:75]
    v_cvt_pk_bf16_f32 v202, v90, v94
    v_mfma_f32_16x16x32_bf16 v[44:47], v[16:19], a[0:3], 0
    ds_read_b128 v[224:227], v4 offset:33152
    buffer_store_dword v114, v6, s[12:15], s42 offen sc1
    v_mfma_f32_16x16x32_bf16 v[44:47], v[20:23], a[4:7], v[44:47]
    ds_read_b128 v[228:231], v4 offset:33280
    v_cvt_pk_bf16_f32 v203, v91, v95
    v_mfma_f32_16x16x32_bf16 v[44:47], v[24:27], a[8:11], v[44:47]
    ds_read_b128 v[232:235], v4 offset:33408
    buffer_store_dword v122, v6, s[12:15], s46 offen sc1
    v_mfma_f32_16x16x32_bf16 v[52:55], v[16:19], a[36:39], 0
    v_permlane16_swap_b32 v196, v200
    v_mfma_f32_16x16x32_bf16 v[52:55], v[20:23], a[40:43], v[52:55]
    buffer_store_dword v115, v6, s[12:15], s43 offen sc1
    v_permlane16_swap_b32 v197, v201
    v_mfma_f32_16x16x32_bf16 v[52:55], v[24:27], a[44:47], v[52:55]
    v_permlane16_swap_b32 v198, v202
    v_mfma_f32_16x16x32_bf16 v[60:63], v[16:19], a[72:75], 0
    v_permlane16_swap_b32 v199, v203
    v_cvt_pk_bf16_f32 v204, v96, v100
    v_mfma_f32_16x16x32_bf16 v[60:63], v[20:23], a[76:79], v[60:63]
    buffer_store_dword v128, v6, s[12:15], s47 offen sc1
    v_mfma_f32_16x16x32_bf16 v[60:63], v[24:27], a[80:83], v[60:63]
    v_cvt_pk_bf16_f32 v205, v97, v101
    v_cvt_pk_bf16_f32 v206, v98, v102
    v_mfma_f32_16x16x32_bf16 v[68:71], v[16:19], a[108:111], 0
    buffer_store_dword v136, v6, s[12:15], s51 offen sc1
    v_mfma_f32_16x16x32_bf16 v[68:71], v[20:23], a[112:115], v[68:71]
    v_cvt_pk_bf16_f32 v207, v99, v103
    v_cvt_pk_bf16_f32 v208, v104, v108
    v_mfma_f32_16x16x32_bf16 v[68:71], v[24:27], a[116:119], v[68:71]
    buffer_store_dword v129, v6, s[12:15], s48 offen sc1
    v_mfma_f32_16x16x32_bf16 v[76:79], v[16:19], a[144:147], 0
    v_cvt_pk_bf16_f32 v209, v105, v109
    v_cvt_pk_bf16_f32 v210, v106, v110
    v_mfma_f32_16x16x32_bf16 v[76:79], v[20:23], a[148:151], v[76:79]
    v_cvt_pk_bf16_f32 v211, v107, v111
    v_mfma_f32_16x16x32_bf16 v[76:79], v[24:27], a[152:155], v[76:79]
    buffer_store_dword v137, v6, s[12:15], s30 offen sc1
    v_permlane16_swap_b32 v204, v208
    s_waitcnt lgkmcnt(0)
    v_mfma_f32_16x16x32_bf16 v[40:43], v[224:227], a[12:15], v[40:43]
    v_pk_add_u16 v16, v224, s66 op_sel:[1,0] op_sel_hi:[0,1]
    v_permlane16_swap_b32 v205, v209
    v_mfma_f32_16x16x32_bf16 v[40:43], v[228:231], a[16:19], v[40:43]
    v_pk_add_u16 v17, v225, s66 op_sel:[1,0] op_sel_hi:[0,1]
    buffer_store_dword v130, v6, s[12:15], s49 offen sc1
    v_mfma_f32_16x16x32_bf16 v[40:43], v[232:235], a[20:23], v[40:43]
    v_pk_add_u16 v18, v226, s66 op_sel:[1,0] op_sel_hi:[0,1]
    v_pk_add_u16 v19, v227, s66 op_sel:[1,0] op_sel_hi:[0,1]
    v_mfma_f32_16x16x32_bf16 v[48:51], v[224:227], a[48:51], v[48:51]
    v_pk_add_u16 v20, v228, s66 op_sel:[1,0] op_sel_hi:[0,1]
    v_permlane16_swap_b32 v206, v210
    v_mfma_f32_16x16x32_bf16 v[48:51], v[228:231], a[52:55], v[48:51]
    v_pk_add_u16 v21, v229, s66 op_sel:[1,0] op_sel_hi:[0,1]
    buffer_store_dword v138, v6, s[12:15], s31 offen sc1
    v_mfma_f32_16x16x32_bf16 v[48:51], v[232:235], a[56:59], v[48:51]
    v_pk_add_u16 v22, v230, s66 op_sel:[1,0] op_sel_hi:[0,1]
    v_pk_add_u16 v23, v231, s66 op_sel:[1,0] op_sel_hi:[0,1]
    v_mfma_f32_16x16x32_bf16 v[56:59], v[224:227], a[84:87], v[56:59]
    v_pk_add_u16 v24, v232, s66 op_sel:[1,0] op_sel_hi:[0,1]
    buffer_store_dword v131, v6, s[12:15], s50 offen sc1
    v_add_u32 v6, 4194304, v6
    v_mfma_f32_16x16x32_bf16 v[56:59], v[228:231], a[88:91], v[56:59]
    v_pk_add_u16 v25, v233, s66 op_sel:[1,0] op_sel_hi:[0,1]
    v_permlane16_swap_b32 v207, v211
    v_mfma_f32_16x16x32_bf16 v[56:59], v[232:235], a[92:95], v[56:59]
    v_pk_add_u16 v26, v234, s66 op_sel:[1,0] op_sel_hi:[0,1]
    v_pk_add_u16 v27, v235, s66 op_sel:[1,0] op_sel_hi:[0,1]
    v_mfma_f32_16x16x32_bf16 v[64:67], v[224:227], a[120:123], v[64:67]
    buffer_store_dword v144, v8, s[12:15], 0 offen sc1
    v_mfma_f32_16x16x32_bf16 v[64:67], v[228:231], a[124:127], v[64:67]
    v_mfma_f32_16x16x32_bf16 v[64:67], v[232:235], a[128:131], v[64:67]
    buffer_store_dword v145, v8, s[12:15], s41 offen sc1
    v_mfma_f32_16x16x32_bf16 v[72:75], v[224:227], a[156:159], v[72:75]
    v_mfma_f32_16x16x32_bf16 v[72:75], v[228:231], a[160:163], v[72:75]
    buffer_store_dword v146, v8, s[12:15], s42 offen sc1
    v_mfma_f32_16x16x32_bf16 v[72:75], v[232:235], a[164:167], v[72:75]
    v_mfma_f32_16x16x32_bf16 v[44:47], v[16:19], a[12:15], v[44:47]
    ds_read_b128 v[212:215], v4 offset:33536
    buffer_store_dword v147, v9, s[12:15], s43 offen sc1
    v_add_u32 v8, 4194304, v8
    v_add_u32 v9, 4194304, v9
    v_mfma_f32_16x16x32_bf16 v[44:47], v[20:23], a[16:19], v[44:47]
    ds_read_b128 v[216:219], v4 offset:33664
    v_mfma_f32_16x16x32_bf16 v[44:47], v[24:27], a[20:23], v[44:47]
    ds_read_b128 v[220:223], v4 offset:33792
    v_mfma_f32_16x16x32_bf16 v[52:55], v[16:19], a[48:51], v[52:55]
    buffer_store_dword v196, v7, s[12:15], 0 offen sc1
    v_mfma_f32_16x16x32_bf16 v[52:55], v[20:23], a[52:55], v[52:55]
    v_mfma_f32_16x16x32_bf16 v[52:55], v[24:27], a[56:59], v[52:55]
    buffer_store_dword v200, v7, s[12:15], s44 offen sc1
    v_mfma_f32_16x16x32_bf16 v[60:63], v[16:19], a[84:87], v[60:63]
    v_mfma_f32_16x16x32_bf16 v[60:63], v[20:23], a[88:91], v[60:63]
    v_mfma_f32_16x16x32_bf16 v[60:63], v[24:27], a[92:95], v[60:63]
    buffer_store_dword v197, v7, s[12:15], s41 offen sc1
    v_mfma_f32_16x16x32_bf16 v[68:71], v[16:19], a[120:123], v[68:71]
    v_mfma_f32_16x16x32_bf16 v[68:71], v[20:23], a[124:127], v[68:71]
    buffer_store_dword v201, v7, s[12:15], s45 offen sc1
    v_mfma_f32_16x16x32_bf16 v[68:71], v[24:27], a[128:131], v[68:71]
    v_mfma_f32_16x16x32_bf16 v[76:79], v[16:19], a[156:159], v[76:79]
    buffer_store_dword v198, v7, s[12:15], s42 offen sc1
    v_mfma_f32_16x16x32_bf16 v[76:79], v[20:23], a[160:163], v[76:79]
    v_mfma_f32_16x16x32_bf16 v[76:79], v[24:27], a[164:167], v[76:79]
    s_waitcnt lgkmcnt(0)
    v_mfma_f32_16x16x32_bf16 v[40:43], v[212:215], a[24:27], v[40:43]
    v_pk_add_u16 v16, v212, s66 op_sel:[1,0] op_sel_hi:[0,1]
    buffer_store_dword v202, v7, s[12:15], s46 offen sc1
    s_waitcnt vmcnt(24)
    s_barrier
    s_cmp_lg_u32 s20, 0
    s_cbranch_scc1 L_sg_y1
    v_mov_b32 v157, s25
    s_mov_b32 s3, 32768
    s_mov_b64 exec, 1
    buffer_store_dword v157, v156, s[12:15], s3 offen sc1
    s_mov_b64 exec, -1
L_sg_y1:
    v_mfma_f32_16x16x32_bf16 v[40:43], v[216:219], a[28:31], v[40:43]
    v_pk_add_u16 v17, v213, s66 op_sel:[1,0] op_sel_hi:[0,1]
    v_mfma_f32_16x16x32_bf16 v[40:43], v[220:223], a[32:35], v[40:43]
    v_pk_add_u16 v18, v214, s66 op_sel:[1,0] op_sel_hi:[0,1]
    v_pk_add_u16 v19, v215, s66 op_sel:[1,0] op_sel_hi:[0,1]
    v_mfma_f32_16x16x32_bf16 v[48:51], v[212:215], a[60:63], v[48:51]
    v_pk_add_u16 v20, v216, s66 op_sel:[1,0] op_sel_hi:[0,1]
    buffer_store_dword v199, v7, s[12:15], s43 offen sc1
    v_mfma_f32_16x16x32_bf16 v[48:51], v[216:219], a[64:67], v[48:51]
    v_pk_add_u16 v21, v217, s66 op_sel:[1,0] op_sel_hi:[0,1]
    v_mfma_f32_16x16x32_bf16 v[48:51], v[220:223], a[68:71], v[48:51]
    v_pk_add_u16 v22, v218, s66 op_sel:[1,0] op_sel_hi:[0,1]
    v_pk_add_u16 v23, v219, s66 op_sel:[1,0] op_sel_hi:[0,1]
    v_mfma_f32_16x16x32_bf16 v[56:59], v[212:215], a[96:99], v[56:59]
    v_pk_add_u16 v24, v220, s66 op_sel:[1,0] op_sel_hi:[0,1]
    buffer_store_dword v204, v7, s[12:15], s47 offen sc1
    v_mfma_f32_16x16x32_bf16 v[56:59], v[216:219], a[100:103], v[56:59]
    v_pk_add_u16 v25, v221, s66 op_sel:[1,0] op_sel_hi:[0,1]
    buffer_store_dword v208, v7, s[12:15], s51 offen sc1
    v_mfma_f32_16x16x32_bf16 v[56:59], v[220:223], a[104:107], v[56:59]
    v_pk_add_u16 v26, v222, s66 op_sel:[1,0] op_sel_hi:[0,1]
    v_pk_add_u16 v27, v223, s66 op_sel:[1,0] op_sel_hi:[0,1]
    v_mfma_f32_16x16x32_bf16 v[64:67], v[212:215], a[132:135], v[64:67]
    buffer_store_dword v205, v7, s[12:15], s48 offen sc1
    v_mfma_f32_16x16x32_bf16 v[64:67], v[216:219], a[136:139], v[64:67]
    v_mfma_f32_16x16x32_bf16 v[64:67], v[220:223], a[140:143], v[64:67]
    v_mfma_f32_16x16x32_bf16 v[72:75], v[212:215], a[168:171], v[72:75]
    buffer_store_dword v209, v7, s[12:15], s30 offen sc1
    v_mfma_f32_16x16x32_bf16 v[72:75], v[216:219], a[172:175], v[72:75]
    v_mfma_f32_16x16x32_bf16 v[72:75], v[220:223], a[176:179], v[72:75]
    buffer_store_dword v206, v7, s[12:15], s49 offen sc1
    v_mfma_f32_16x16x32_bf16 v[44:47], v[16:19], a[24:27], v[44:47]
    ds_read_b128 v[224:227], v5 offset:32768
    v_mfma_f32_16x16x32_bf16 v[44:47], v[20:23], a[28:31], v[44:47]
    ds_read_b128 v[228:231], v5 offset:32896
    buffer_store_dword v210, v7, s[12:15], s31 offen sc1
    v_mfma_f32_16x16x32_bf16 v[44:47], v[24:27], a[32:35], v[44:47]
    ds_read_b128 v[232:235], v5 offset:33024
    v_mfma_f32_16x16x32_bf16 v[52:55], v[16:19], a[60:63], v[52:55]
    v_mfma_f32_16x16x32_bf16 v[52:55], v[20:23], a[64:67], v[52:55]
    buffer_store_dword v207, v7, s[12:15], s50 offen sc1
    v_add_u32 v7, 4194304, v7
    v_mfma_f32_16x16x32_bf16 v[52:55], v[24:27], a[68:71], v[52:55]
    v_mfma_f32_16x16x32_bf16 v[60:63], v[16:19], a[96:99], v[60:63]
    v_mfma_f32_16x16x32_bf16 v[60:63], v[20:23], a[100:103], v[60:63]
    v_mfma_f32_16x16x32_bf16 v[60:63], v[24:27], a[104:107], v[60:63]
    v_mfma_f32_16x16x32_bf16 v[68:71], v[16:19], a[132:135], v[68:71]
    v_mfma_f32_16x16x32_bf16 v[68:71], v[20:23], a[136:139], v[68:71]
    v_mfma_f32_16x16x32_bf16 v[68:71], v[24:27], a[140:143], v[68:71]
    v_mfma_f32_16x16x32_bf16 v[76:79], v[16:19], a[168:171], v[76:79]
    v_mfma_f32_16x16x32_bf16 v[76:79], v[20:23], a[172:175], v[76:79]
    v_mfma_f32_16x16x32_bf16 v[76:79], v[24:27], a[176:179], v[76:79]
    s_waitcnt lgkmcnt(0)
    v_mfma_f32_16x16x32_bf16 v[80:83], v[224:227], a[0:3], 0
    v_pk_add_u16 v16, v224, s66 op_sel:[1,0] op_sel_hi:[0,1]
    v_pk_add_u16 v17, v225, s66 op_sel:[1,0] op_sel_hi:[0,1]
    v_mfma_f32_16x16x32_bf16 v[80:83], v[228:231], a[4:7], v[80:83]
    v_pk_add_u16 v18, v226, s66 op_sel:[1,0] op_sel_hi:[0,1]
    v_pk_add_u16 v19, v227, s66 op_sel:[1,0] op_sel_hi:[0,1]
    v_mfma_f32_16x16x32_bf16 v[80:83], v[232:235], a[8:11], v[80:83]
    v_pk_add_u16 v20, v228, s66 op_sel:[1,0] op_sel_hi:[0,1]
    v_pk_add_u16 v21, v229, s66 op_sel:[1,0] op_sel_hi:[0,1]
    v_mfma_f32_16x16x32_bf16 v[88:91], v[224:227], a[36:39], 0
    v_pk_add_u16 v22, v230, s66 op_sel:[1,0] op_sel_hi:[0,1]
    v_mfma_f32_16x16x32_bf16 v[88:91], v[228:231], a[40:43], v[88:91]
    v_pk_add_u16 v23, v231, s66 op_sel:[1,0] op_sel_hi:[0,1]
    v_mfma_f32_16x16x32_bf16 v[88:91], v[232:235], a[44:47], v[88:91]
    v_pk_add_u16 v24, v232, s66 op_sel:[1,0] op_sel_hi:[0,1]
    v_pk_add_u16 v25, v233, s66 op_sel:[1,0] op_sel_hi:[0,1]
    v_mfma_f32_16x16x32_bf16 v[96:99], v[224:227], a[72:75], 0
    v_pk_add_u16 v26, v234, s66 op_sel:[1,0] op_sel_hi:[0,1]
    v_mfma_f32_16x16x32_bf16 v[96:99], v[228:231], a[76:79], v[96:99]
    v_pk_add_u16 v27, v235, s66 op_sel:[1,0] op_sel_hi:[0,1]
    v_cvt_pk_bf16_f32 v40, v40, v44
    v_mfma_f32_16x16x32_bf16 v[96:99], v[232:235], a[80:83], v[96:99]
    v_cvt_pk_bf16_f32 v41, v41, v45
    v_mfma_f32_16x16x32_bf16 v[104:107], v[224:227], a[108:111], 0
    v_cvt_pk_bf16_f32 v42, v42, v46
    v_cvt_pk_bf16_f32 v43, v43, v47
    v_mfma_f32_16x16x32_bf16 v[104:107], v[228:231], a[112:115], v[104:107]
    v_cvt_pk_bf16_f32 v48, v48, v52
    v_mfma_f32_16x16x32_bf16 v[104:107], v[232:235], a[116:119], v[104:107]
    v_cvt_pk_bf16_f32 v49, v49, v53
    v_cvt_pk_bf16_f32 v50, v50, v54
    v_mfma_f32_16x16x32_bf16 v[84:87], v[16:19], a[0:3], 0
    ds_read_b128 v[212:215], v5 offset:33152
    v_cvt_pk_bf16_f32 v51, v51, v55
    v_mfma_f32_16x16x32_bf16 v[84:87], v[20:23], a[4:7], v[84:87]
    ds_read_b128 v[216:219], v5 offset:33280
    v_permlane16_swap_b32 v40, v48
    v_mfma_f32_16x16x32_bf16 v[84:87], v[24:27], a[8:11], v[84:87]
    ds_read_b128 v[220:223], v5 offset:33408
    v_permlane16_swap_b32 v41, v49
    v_mfma_f32_16x16x32_bf16 v[92:95], v[16:19], a[36:39], 0
    v_permlane16_swap_b32 v42, v50
    v_permlane16_swap_b32 v43, v51
    v_mfma_f32_16x16x32_bf16 v[92:95], v[20:23], a[40:43], v[92:95]
    buffer_store_dword v40, v6, s[12:15], 0 offen sc1
    v_mfma_f32_16x16x32_bf16 v[92:95], v[24:27], a[44:47], v[92:95]
    buffer_store_dword v48, v6, s[12:15], s44 offen sc1
    v_cvt_pk_bf16_f32 v56, v56, v60
    v_mfma_f32_16x16x32_bf16 v[100:103], v[16:19], a[72:75], 0
    v_cvt_pk_bf16_f32 v57, v57, v61
    v_mfma_f32_16x16x32_bf16 v[100:103], v[20:23], a[76:79], v[100:103]
    buffer_store_dword v41, v6, s[12:15], s41 offen sc1
    v_cvt_pk_bf16_f32 v58, v58, v62
    v_mfma_f32_16x16x32_bf16 v[100:103], v[24:27], a[80:83], v[100:103]
    v_cvt_pk_bf16_f32 v59, v59, v63
    v_mfma_f32_16x16x32_bf16 v[108:111], v[16:19], a[108:111], 0
    v_cvt_pk_bf16_f32 v64, v64, v68
    v_cvt_pk_bf16_f32 v65, v65, v69
    v_mfma_f32_16x16x32_bf16 v[108:111], v[20:23], a[112:115], v[108:111]
    buffer_store_dword v49, v6, s[12:15], s45 offen sc1
    v_mfma_f32_16x16x32_bf16 v[108:111], v[24:27], a[116:119], v[108:111]
    v_cvt_pk_bf16_f32 v66, v66, v70
    v_cvt_pk_bf16_f32 v67, v67, v71
    s_waitcnt lgkmcnt(0)
    v_mfma_f32_16x16x32_bf16 v[80:83], v[212:215], a[12:15], v[80:83]
    v_pk_add_u16 v16, v212, s66 op_sel:[1,0] op_sel_hi:[0,1]
    v_pk_add_u16 v17, v213, s66 op_sel:[1,0] op_sel_hi:[0,1]
    v_mfma_f32_16x16x32_bf16 v[80:83], v[216:219], a[16:19], v[80:83]
    v_pk_add_u16 v18, v214, s66 op_sel:[1,0] op_sel_hi:[0,1]
    v_pk_add_u16 v19, v215, s66 op_sel:[1,0] op_sel_hi:[0,1]
    v_mfma_f32_16x16x32_bf16 v[80:83], v[220:223], a[20:23], v[80:83]
    v_pk_add_u16 v20, v216, s66 op_sel:[1,0] op_sel_hi:[0,1]
    v_pk_add_u16 v21, v217, s66 op_sel:[1,0] op_sel_hi:[0,1]
    v_mfma_f32_16x16x32_bf16 v[88:91], v[212:215], a[48:51], v[88:91]
    v_pk_add_u16 v22, v218, s66 op_sel:[1,0] op_sel_hi:[0,1]
    buffer_store_dword v42, v6, s[12:15], s42 offen sc1
    v_mfma_f32_16x16x32_bf16 v[88:91], v[216:219], a[52:55], v[88:91]
    v_pk_add_u16 v23, v219, s66 op_sel:[1,0] op_sel_hi:[0,1]
    buffer_store_dword v50, v6, s[12:15], s46 offen sc1
    v_mfma_f32_16x16x32_bf16 v[88:91], v[220:223], a[56:59], v[88:91]
    v_pk_add_u16 v24, v220, s66 op_sel:[1,0] op_sel_hi:[0,1]
    v_pk_add_u16 v25, v221, s66 op_sel:[1,0] op_sel_hi:[0,1]
    v_mfma_f32_16x16x32_bf16 v[96:99], v[212:215], a[84:87], v[96:99]
    v_pk_add_u16 v26, v222, s66 op_sel:[1,0] op_sel_hi:[0,1]
    buffer_store_dword v43, v6, s[12:15], s43 offen sc1
    v_mfma_f32_16x16x32_bf16 v[96:99], v[216:219], a[88:91], v[96:99]
    v_pk_add_u16 v27, v223, s66 op_sel:[1,0] op_sel_hi:[0,1]
    v_permlane16_swap_b32 v56, v64
    v_mfma_f32_16x16x32_bf16 v[96:99], v[220:223], a[92:95], v[96:99]
    v_permlane16_swap_b32 v57, v65
    v_mfma_f32_16x16x32_bf16 v[104:107], v[212:215], a[120:123], v[104:107]
    v_permlane16_swap_b32 v58, v66
    v_permlane16_swap_b32 v59, v67
    v_mfma_f32_16x16x32_bf16 v[104:107], v[216:219], a[124:127], v[104:107]
    buffer_store_dword v56, v6, s[12:15], s47 offen sc1
    v_mfma_f32_16x16x32_bf16 v[104:107], v[220:223], a[128:131], v[104:107]
    v_cvt_pk_bf16_f32 v72, v72, v76
    v_cvt_pk_bf16_f32 v73, v73, v77
    v_mfma_f32_16x16x32_bf16 v[84:87], v[16:19], a[12:15], v[84:87]
    ds_read_b128 v[224:227], v5 offset:33536
    buffer_store_dword v64, v6, s[12:15], s51 offen sc1
    v_mfma_f32_16x16x32_bf16 v[84:87], v[20:23], a[16:19], v[84:87]
    ds_read_b128 v[228:231], v5 offset:33664
    v_cvt_pk_bf16_f32 v74, v74, v78
    v_mfma_f32_16x16x32_bf16 v[84:87], v[24:27], a[20:23], v[84:87]
    ds_read_b128 v[232:235], v5 offset:33792
    buffer_store_dword v57, v6, s[12:15], s48 offen sc1
    v_mfma_f32_16x16x32_bf16 v[92:95], v[16:19], a[48:51], v[92:95]
    v_cvt_pk_bf16_f32 v75, v75, v79
    v_mfma_f32_16x16x32_bf16 v[92:95], v[20:23], a[52:55], v[92:95]
    v_mfma_f32_16x16x32_bf16 v[92:95], v[24:27], a[56:59], v[92:95]
    buffer_store_dword v65, v6, s[12:15], s30 offen sc1
    v_mfma_f32_16x16x32_bf16 v[100:103], v[16:19], a[84:87], v[100:103]
    v_mfma_f32_16x16x32_bf16 v[100:103], v[20:23], a[88:91], v[100:103]
    v_mfma_f32_16x16x32_bf16 v[100:103], v[24:27], a[92:95], v[100:103]
    buffer_store_dword v58, v6, s[12:15], s49 offen sc1
    v_mfma_f32_16x16x32_bf16 v[108:111], v[16:19], a[120:123], v[108:111]
    v_mfma_f32_16x16x32_bf16 v[108:111], v[20:23], a[124:127], v[108:111]
    buffer_store_dword v66, v6, s[12:15], s31 offen sc1
    v_mfma_f32_16x16x32_bf16 v[108:111], v[24:27], a[128:131], v[108:111]
    s_waitcnt lgkmcnt(0)
    v_mfma_f32_16x16x32_bf16 v[80:83], v[224:227], a[24:27], v[80:83]
    v_pk_add_u16 v16, v224, s66 op_sel:[1,0] op_sel_hi:[0,1]
    v_pk_add_u16 v17, v225, s66 op_sel:[1,0] op_sel_hi:[0,1]
    v_mfma_f32_16x16x32_bf16 v[80:83], v[228:231], a[28:31], v[80:83]
    v_pk_add_u16 v18, v226, s66 op_sel:[1,0] op_sel_hi:[0,1]
    v_pk_add_u16 v19, v227, s66 op_sel:[1,0] op_sel_hi:[0,1]
    v_mfma_f32_16x16x32_bf16 v[80:83], v[232:235], a[32:35], v[80:83]
    v_pk_add_u16 v20, v228, s66 op_sel:[1,0] op_sel_hi:[0,1]
    v_pk_add_u16 v21, v229, s66 op_sel:[1,0] op_sel_hi:[0,1]
    v_mfma_f32_16x16x32_bf16 v[88:91], v[224:227], a[60:63], v[88:91]
    v_pk_add_u16 v22, v230, s66 op_sel:[1,0] op_sel_hi:[0,1]
    buffer_store_dword v59, v6, s[12:15], s50 offen sc1
    v_add_u32 v6, 4194304, v6
    v_mfma_f32_16x16x32_bf16 v[88:91], v[228:231], a[64:67], v[88:91]
    v_pk_add_u16 v23, v231, s66 op_sel:[1,0] op_sel_hi:[0,1]
    buffer_store_dword v72, v8, s[12:15], 0 offen sc1
    v_mfma_f32_16x16x32_bf16 v[88:91], v[232:235], a[68:71], v[88:91]
    v_pk_add_u16 v24, v232, s66 op_sel:[1,0] op_sel_hi:[0,1]
    v_pk_add_u16 v25, v233, s66 op_sel:[1,0] op_sel_hi:[0,1]
    v_mfma_f32_16x16x32_bf16 v[96:99], v[224:227], a[96:99], v[96:99]
    v_pk_add_u16 v26, v234, s66 op_sel:[1,0] op_sel_hi:[0,1]
    buffer_store_dword v73, v8, s[12:15], s41 offen sc1
    s_waitcnt vmcnt(16)
    s_barrier
    s_cmp_lg_u32 s20, 0
    s_cbranch_scc1 L_sg_y2
    v_mov_b32 v157, s26
    s_mov_b32 s3, 65536
    s_mov_b64 exec, 1
    buffer_store_dword v157, v156, s[12:15], s3 offen sc1
    s_mov_b64 exec, -1
L_sg_y2:
    v_mfma_f32_16x16x32_bf16 v[96:99], v[228:231], a[100:103], v[96:99]
    v_pk_add_u16 v27, v235, s66 op_sel:[1,0] op_sel_hi:[0,1]
    v_mfma_f32_16x16x32_bf16 v[96:99], v[232:235], a[104:107], v[96:99]
    v_mfma_f32_16x16x32_bf16 v[104:107], v[224:227], a[132:135], v[104:107]
    buffer_store_dword v74, v8, s[12:15], s42 offen sc1
    v_mfma_f32_16x16x32_bf16 v[104:107], v[228:231], a[136:139], v[104:107]
    v_mfma_f32_16x16x32_bf16 v[104:107], v[232:235], a[140:143], v[104:107]
    v_mfma_f32_16x16x32_bf16 v[84:87], v[16:19], a[24:27], v[84:87]
    buffer_store_dword v75, v9, s[12:15], s43 offen sc1
    v_add_u32 v8, 4194304, v8
    v_add_u32 v9, 4194304, v9
    buffer_load_dword v155, v13, s[12:15], 0 offen sc1
    v_mfma_f32_16x16x32_bf16 v[84:87], v[20:23], a[28:31], v[84:87]
    v_mfma_f32_16x16x32_bf16 v[84:87], v[24:27], a[32:35], v[84:87]
    v_mfma_f32_16x16x32_bf16 v[92:95], v[16:19], a[60:63], v[92:95]
    v_mfma_f32_16x16x32_bf16 v[92:95], v[20:23], a[64:67], v[92:95]
    v_mfma_f32_16x16x32_bf16 v[92:95], v[24:27], a[68:71], v[92:95]
    v_mfma_f32_16x16x32_bf16 v[100:103], v[16:19], a[96:99], v[100:103]
    v_mfma_f32_16x16x32_bf16 v[100:103], v[20:23], a[100:103], v[100:103]
    v_mfma_f32_16x16x32_bf16 v[100:103], v[24:27], a[104:107], v[100:103]
    v_mfma_f32_16x16x32_bf16 v[108:111], v[16:19], a[132:135], v[108:111]
    v_mfma_f32_16x16x32_bf16 v[108:111], v[20:23], a[136:139], v[108:111]
    v_mfma_f32_16x16x32_bf16 v[108:111], v[24:27], a[140:143], v[108:111]
    s_cmp_ge_u32 s29, 63
    s_cselect_b32 s33, 1, 0
    s_add_u32 s38, s29, s33
    s_lshl_b32 s38, s38, 15
    s_lshr_b32 s3, s28, 1
    s_xor_b32 s3, s3, s33
    s_lshl_b32 s3, s3, 13
    s_add_u32 s38, s38, s3
    s_and_b32 s3, s28, 1
    s_mul_i32 s3, s3, 12582912
    s_add_u32 s38, s38, s3
    s_lshl_b32 s3, s32, 7
    s_add_u32 s38, s38, s3
    s_add_u32 s38, s38, 29360128
    s_mul_i32 s39, s20, 24576
    v_lshrrev_b32 v3, 3, v1
    v_lshl_add_u32 v5, v3, 7, v2
    v_cvt_pk_bf16_f32 v80, v80, v84
    v_cvt_pk_bf16_f32 v81, v81, v85
    v_cvt_pk_bf16_f32 v82, v82, v86
    v_cvt_pk_bf16_f32 v83, v83, v87
    v_cvt_pk_bf16_f32 v88, v88, v92
    v_cvt_pk_bf16_f32 v89, v89, v93
    v_cvt_pk_bf16_f32 v90, v90, v94
    v_cvt_pk_bf16_f32 v91, v91, v95
    v_permlane16_swap_b32 v80, v88
    v_permlane16_swap_b32 v81, v89
    v_permlane16_swap_b32 v82, v90
    v_permlane16_swap_b32 v83, v91
    buffer_store_dword v80, v7, s[12:15], 0 offen sc1
    v_cvt_pk_bf16_f32 v96, v96, v100
    buffer_store_dword v88, v7, s[12:15], s44 offen sc1
    v_cvt_pk_bf16_f32 v97, v97, v101
    buffer_store_dword v81, v7, s[12:15], s41 offen sc1
    v_cvt_pk_bf16_f32 v98, v98, v102
    buffer_store_dword v89, v7, s[12:15], s45 offen sc1
    v_cvt_pk_bf16_f32 v99, v99, v103
    buffer_store_dword v82, v7, s[12:15], s42 offen sc1
    v_cvt_pk_bf16_f32 v104, v104, v108
    buffer_store_dword v90, v7, s[12:15], s46 offen sc1
    v_cvt_pk_bf16_f32 v105, v105, v109
    buffer_store_dword v83, v7, s[12:15], s43 offen sc1
    v_cvt_pk_bf16_f32 v106, v106, v110
    v_cvt_pk_bf16_f32 v107, v107, v111
    v_permlane16_swap_b32 v96, v104
    v_permlane16_swap_b32 v97, v105
    v_permlane16_swap_b32 v98, v106
    v_permlane16_swap_b32 v99, v107
    buffer_store_dword v96, v7, s[12:15], s47 offen sc1
    buffer_store_dword v104, v7, s[12:15], s51 offen sc1
    buffer_store_dword v97, v7, s[12:15], s48 offen sc1
    buffer_store_dword v105, v7, s[12:15], s30 offen sc1
    buffer_store_dword v98, v7, s[12:15], s49 offen sc1
    buffer_store_dword v106, v7, s[12:15], s31 offen sc1
    buffer_store_dword v99, v7, s[12:15], s50 offen sc1
    v_add_u32 v7, 4194304, v7
    s_cmp_ge_u32 s23, 252
    s_cbranch_scc0 L_p3
    s_waitcnt vmcnt(0)
    s_barrier
    s_cmp_lg_u32 s20, 0
    s_cbranch_scc1 L_sg_y3x
    v_mov_b32 v157, s27
    s_mov_b32 s3, 98304
    s_mov_b64 exec, 1
    buffer_store_dword v157, v156, s[12:15], s3 offen sc1
    s_mov_b64 exec, -1
L_sg_y3x:
    v_lshlrev_b32 v13, 7, v0
    v_add_u32 v13, 54558720, v13
    v_mov_b32 v155, 0
L_spin_clr:
    v_cmp_ne_u32 vcc, s25, v155
    s_add_u32 s67, s67, 1
    s_cmp_ge_u32 s67, 120000
    s_cbranch_scc1 L_go_clr
    s_cbranch_vccz L_go_clr
    s_sleep 8
    buffer_load_dword v155, v13, s[12:15], 0 offen sc1
    s_waitcnt vmcnt(0)
    s_branch L_spin_clr
L_go_clr:
    s_barrier
    s_cmp_lg_u32 s20, 0
    s_cbranch_scc1 L_fin
    s_lshl_b32 s3, s28, 2
    v_mov_b32 v10, s3
    v_mov_b32 v8, 0
    s_mov_b64 exec, 1
    buffer_store_dword v8, v10, s[56:59], 0 offen sc1
    buffer_store_dword v8, v8, s[56:59], 0 offen offset:16 sc1
    s_mov_b64 exec, -1
    s_branch L_fin
L_p3:
    s_waitcnt vmcnt(14)
L_spin_y0:
    v_cmp_ne_u32 vcc, s25, v155
    s_add_u32 s67, s67, 1
    s_cmp_ge_u32 s67, 120000
    s_cbranch_scc1 L_go_y0
    s_cbranch_vccz L_go_y0
    s_sleep 2
    buffer_load_dword v155, v13, s[12:15], 0 offen sc1
    s_waitcnt vmcnt(0)
    s_branch L_spin_y0
L_go_y0:
    s_barrier
    v_add_u32 v13, 32768, v13
    s_add_u32 m0, s39, 0
    s_nop 0
    buffer_load_dwordx4 v5, s[12:15], s38 offen offset:0 sc1 lds
    s_add_u32 s38, s38, 1024
    buffer_load_dwordx4 v5, s[12:15], s38 offen offset:1024 sc1 lds
    s_add_u32 s38, s38, 1024
    buffer_load_dwordx4 v5, s[12:15], s38 offen offset:2048 sc1 lds
    s_add_u32 s38, s38, 1024
    buffer_load_dwordx4 v5, s[12:15], s38 offen offset:3072 sc1 lds
    s_waitcnt vmcnt(4)
    s_barrier
    s_cmp_lg_u32 s20, 0
    s_cbranch_scc1 L_sg_y3
    v_mov_b32 v157, s27
    s_mov_b32 s3, 98304
    s_mov_b64 exec, 1
    buffer_store_dword v157, v156, s[12:15], s3 offen sc1
    s_mov_b64 exec, -1
L_sg_y3:
    s_mul_i32 s33, s29, 7282
    s_lshr_b32 s33, s33, 16
    s_mul_i32 s3, s33, 9
    s_sub_u32 s34, s29, s3
    s_lshr_b32 s3, s28, 1
    s_mul_i32 s3, s3, 4608000
    s_add_u32 s16, s52, s3
    s_addc_u32 s17, s53, 0
    s_mov_b32 s18, 4608000
    s_mov_b32 s19, 0x00020000
    s_and_b32 s3, s28, 1
    s_mul_i32 s3, s3, 42
    s_add_u32 s33, s33, s3
    s_mul_i32 s33, s33, 55296
    s_mul_i32 s3, s32, 288
    s_add_u32 s33, s33, s3
    s_lshl_b32 s3, s34, 5
    s_add_u32 s33, s33, s3
    v_and_b32 v3, 31, v1
    v_lshrrev_b32 v4, 5, v1
    v_mul_u32_u24 v6, 576, v3
    v_lshl_add_u32 v6, v4, 4, v6
    v_add_u32 v6, s33, v6
    v_bfe_u32 v7, v1, 1, 2
    v_add_u32 v7, s23, v7
    v_mul_u32_u24 v8, 3641, v7
    v_lshrrev_b32 v8, 16, v8
    v_lshlrev_b32 v7, 5, v7
    v_mul_u32_u24 v8, 54720, v8
    v_and_b32 v9, 1, v1
    v_lshl_add_u32 v7, v9, 4, v7
    v_lshrrev_b32 v9, 3, v1
    v_mul_u32_u24 v6, 576, v9
    v_add3_u32 v6, v6, v7, v8
    s_and_b32 s3, s28, 1
    s_mul_i32 s3, s3, 2322432
    s_mul_i32 s33, s20, 4608
    s_add_u32 s3, s3, s33
    v_add_u32 v6, s3, v6
    v_xor_b32 v8, v9, v1
    v_and_b32 v8, 7, v8
    v_lshlrev_b32 v8, 4, v8
    v_lshl_add_u32 v8, v9, 7, v8
    s_lshl_b32 s3, s20, 10
    s_add_u32 s3, s3, 98304
    v_add_u32 v8, s3, v8
    s_lshl_b32 s3, s20, 1
    v_add_u32 v7, s3, v4
    v_xor_b32 v7, v7, v1
    v_and_b32 v7, 7, v7
    v_lshlrev_b32 v7, 4, v7
    v_lshl_add_u32 v7, v3, 7, v7
    v_add_u32 v7, 98304, v7
    v_lshl_add_u32 v4, v1, 2, s39
    s_mov_b32 s33, 0x7fffffff
    s_waitcnt vmcnt(3)
    ds_read2st64_b32 v[16:17], v4 offset0:0 offset1:1
    ds_read2st64_b32 v[18:19], v4 offset0:2 offset1:3
    s_add_u32 m0, s39, 4096
    s_add_u32 s38, s38, 13312
    buffer_load_dwordx4 v5, s[12:15], s38 offen offset:0 sc1 lds
    s_waitcnt vmcnt(3)
    ds_read2st64_b32 v[20:21], v4 offset0:4 offset1:5
    ds_read2st64_b32 v[22:23], v4 offset0:6 offset1:7
    s_add_u32 s38, s38, 1024
    buffer_load_dwordx4 v5, s[12:15], s38 offen offset:1024 sc1 lds
    buffer_load_dword v155, v13, s[12:15], 0 offen sc1
    s_waitcnt lgkmcnt(2)
    v_mfma_f32_32x32x16_bf16 v[32:47], v[16:19], a[180:183], 0
    v_mfma_f32_32x32x16_bf16 v[48:63], v[16:19], a[212:215], 0
    v_mfma_f32_32x32x16_bf16 v[64:79], v[16:19], a[244:247], 0
    s_waitcnt vmcnt(4)
    ds_read2st64_b32 v[24:25], v4 offset0:8 offset1:9
    ds_read2st64_b32 v[26:27], v4 offset0:10 offset1:11
    s_add_u32 s38, s38, 1024
    buffer_load_dwordx4 v5, s[12:15], s38 offen offset:2048 sc1 lds
    s_waitcnt lgkmcnt(2)
    v_mfma_f32_32x32x16_bf16 v[32:47], v[20:23], a[184:187], v[32:47]
    v_mfma_f32_32x32x16_bf16 v[48:63], v[20:23], a[216:219], v[48:63]
    v_mfma_f32_32x32x16_bf16 v[64:79], v[20:23], a[248:251], v[64:79]
    s_waitcnt vmcnt(4)
    ds_read2st64_b32 v[28:29], v4 offset0:12 offset1:13
    ds_read2st64_b32 v[30:31], v4 offset0:14 offset1:15
    s_add_u32 s38, s38, 1024
    buffer_load_dwordx4 v5, s[12:15], s38 offen offset:3072 sc1 lds
    s_waitcnt lgkmcnt(2)
    v_mfma_f32_32x32x16_bf16 v[32:47], v[24:27], a[188:191], v[32:47]
    v_mfma_f32_32x32x16_bf16 v[48:63], v[24:27], a[220:223], v[48:63]
    v_mfma_f32_32x32x16_bf16 v[64:79], v[24:27], a[252:255], v[64:79]
    s_waitcnt vmcnt(4)
    ds_read2st64_b32 v[16:17], v4 offset0:16 offset1:17
    ds_read2st64_b32 v[18:19], v4 offset0:18 offset1:19
    s_waitcnt vmcnt(2)
L_spin_y1:
    v_cmp_ne_u32 vcc, s26, v155
    s_add_u32 s67, s67, 1
    s_cmp_ge_u32 s67, 120000
    s_cbranch_scc1 L_go_y1
    s_cbranch_vccz L_go_y1
    s_sleep 2
    buffer_load_dword v155, v13, s[12:15], 0 offen sc1
    s_waitcnt vmcnt(0)
    s_branch L_spin_y1
L_go_y1:
    s_barrier
    v_add_u32 v13, 32768, v13
    s_add_u32 m0, s39, 8192
    s_add_u32 s38, s38, 4174848
    buffer_load_dwordx4 v5, s[12:15], s38 offen offset:0 sc1 lds
    s_waitcnt lgkmcnt(2)
    v_mfma_f32_32x32x16_bf16 v[32:47], v[28:31], a[192:195], v[32:47]
    v_mfma_f32_32x32x16_bf16 v[48:63], v[28:31], a[224:227], v[48:63]
    v_mfma_f32_32x32x16_bf16 v[64:79], v[28:31], v[236:239], v[64:79]
    s_waitcnt vmcnt(4)
    ds_read2st64_b32 v[20:21], v4 offset0:20 offset1:21
    ds_read2st64_b32 v[22:23], v4 offset0:22 offset1:23
    s_add_u32 s38, s38, 1024
    buffer_load_dwordx4 v5, s[12:15], s38 offen offset:1024 sc1 lds
    s_waitcnt lgkmcnt(2)
    v_mfma_f32_32x32x16_bf16 v[32:47], v[16:19], a[196:199], v[32:47]
    v_mfma_f32_32x32x16_bf16 v[48:63], v[16:19], a[228:231], v[48:63]
    v_mfma_f32_32x32x16_bf16 v[64:79], v[16:19], v[240:243], v[64:79]
    s_waitcnt vmcnt(3)
    ds_read2st64_b32 v[24:25], v4 offset0:24 offset1:25
    ds_read2st64_b32 v[26:27], v4 offset0:26 offset1:27
    s_add_u32 s38, s38, 1024
    buffer_load_dwordx4 v5, s[12:15], s38 offen offset:2048 sc1 lds
    s_waitcnt lgkmcnt(2)
    v_mfma_f32_32x32x16_bf16 v[32:47], v[20:23], a[200:203], v[32:47]
    v_mfma_f32_32x32x16_bf16 v[48:63], v[20:23], a[232:235], v[48:63]
    v_mfma_f32_32x32x16_bf16 v[64:79], v[20:23], v[244:247], v[64:79]
    s_waitcnt vmcnt(3)
    ds_read2st64_b32 v[28:29], v4 offset0:28 offset1:29
    ds_read2st64_b32 v[30:31], v4 offset0:30 offset1:31
    s_add_u32 s38, s38, 1024
    buffer_load_dwordx4 v5, s[12:15], s38 offen offset:3072 sc1 lds
    s_waitcnt lgkmcnt(2)
    v_mfma_f32_32x32x16_bf16 v[32:47], v[24:27], a[204:207], v[32:47]
    v_mfma_f32_32x32x16_bf16 v[48:63], v[24:27], a[236:239], v[48:63]
    v_mfma_f32_32x32x16_bf16 v[64:79], v[24:27], v[248:251], v[64:79]
    s_waitcnt vmcnt(3)
    ds_read2st64_b32 v[16:17], v4 offset0:32 offset1:33
    ds_read2st64_b32 v[18:19], v4 offset0:34 offset1:35
    s_add_u32 m0, s39, 12288
    s_add_u32 s38, s38, 13312
    buffer_load_dwordx4 v5, s[12:15], s38 offen offset:0 sc1 lds
    s_waitcnt lgkmcnt(2)
    v_mfma_f32_32x32x16_bf16 v[32:47], v[28:31], a[208:211], v[32:47]
    v_mfma_f32_32x32x16_bf16 v[48:63], v[28:31], a[240:243], v[48:63]
    v_mfma_f32_32x32x16_bf16 v[64:79], v[28:31], v[252:255], v[64:79]
    s_waitcnt vmcnt(3)
    ds_read2st64_b32 v[20:21], v4 offset0:36 offset1:37
    ds_read2st64_b32 v[22:23], v4 offset0:38 offset1:39
    s_add_u32 s38, s38, 1024
    buffer_load_dwordx4 v5, s[12:15], s38 offen offset:1024 sc1 lds
    buffer_load_dword v155, v13, s[12:15], 0 offen sc1
    s_nop 9
    v_exp_f32 v128, -abs(v32)
    v_exp_f32 v40, v40
    v_exp_f32 v129, -abs(v33)
    v_exp_f32 v41, v41
    v_exp_f32 v130, -abs(v34)
    v_exp_f32 v42, v42
    s_waitcnt lgkmcnt(2)
    v_mfma_f32_32x32x16_bf16 v[80:95], v[16:19], a[180:183], 0
    v_exp_f32 v131, -abs(v35)
    v_exp_f32 v43, v43
    v_exp_f32 v132, -abs(v36)
    v_exp_f32 v44, v44
    v_exp_f32 v133, -abs(v37)
    v_exp_f32 v45, v45
    v_mfma_f32_32x32x16_bf16 v[96:111], v[16:19], a[212:215], 0
    v_exp_f32 v134, -abs(v38)
    v_exp_f32 v46, v46
    v_exp_f32 v135, -abs(v39)
    v_exp_f32 v47, v47
    v_fma_f32 v128, v128, v128, 1.0
    v_fma_f32 v129, v129, v129, 1.0
    v_fma_f32 v130, v130, v130, 1.0
    v_fma_f32 v131, v131, v131, 1.0
    v_mfma_f32_32x32x16_bf16 v[112:127], v[16:19], a[244:247], 0
    v_fma_f32 v132, v132, v132, 1.0
    v_fma_f32 v133, v133, v133, 1.0
    v_fma_f32 v134, v134, v134, 1.0
    v_fma_f32 v135, v135, v135, 1.0
    v_sub_f32 v144, 2.0, v128
    v_fmac_f32 v128, v40, v128
    v_sub_f32 v145, 2.0, v129
    v_fmac_f32 v129, v41, v129
    v_sub_f32 v146, 2.0, v130
    v_fmac_f32 v130, v42, v130
    v_sub_f32 v147, 2.0, v131
    v_fmac_f32 v131, v43, v131
    s_waitcnt vmcnt(4)
    ds_read2st64_b32 v[24:25], v4 offset0:40 offset1:41
    ds_read2st64_b32 v[26:27], v4 offset0:42 offset1:43
    s_add_u32 s38, s38, 1024
    buffer_load_dwordx4 v5, s[12:15], s38 offen offset:2048 sc1 lds
    v_sub_f32 v148, 2.0, v132
    v_fmac_f32 v132, v44, v132
    v_sub_f32 v149, 2.0, v133
    v_fmac_f32 v133, v45, v133
    v_sub_f32 v150, 2.0, v134
    v_fmac_f32 v134, v46, v134
    v_sub_f32 v151, 2.0, v135
    v_fmac_f32 v135, v47, v135
    v_rcp_f32 v128, v128
    v_bfi_b32 v32, s33, v144, v32
    v_rcp_f32 v129, v129
    s_waitcnt lgkmcnt(2)
    v_mfma_f32_32x32x16_bf16 v[80:95], v[20:23], a[184:187], v[80:95]
    v_bfi_b32 v33, s33, v145, v33
    v_rcp_f32 v130, v130
    v_bfi_b32 v34, s33, v146, v34
    v_rcp_f32 v131, v131
    v_bfi_b32 v35, s33, v147, v35
    v_rcp_f32 v132, v132
    v_bfi_b32 v36, s33, v148, v36
    v_rcp_f32 v133, v133
    v_mfma_f32_32x32x16_bf16 v[96:111], v[20:23], a[216:219], v[96:111]
    v_bfi_b32 v37, s33, v149, v37
    v_rcp_f32 v134, v134
    v_bfi_b32 v38, s33, v150, v38
    v_rcp_f32 v135, v135
    v_bfi_b32 v39, s33, v151, v39
    v_mul_f32 v32, v32, v128
    v_mul_f32 v33, v33, v129
    v_mul_f32 v34, v34, v130
    v_mul_f32 v35, v35, v131
    v_mul_f32 v36, v36, v132
    v_mfma_f32_32x32x16_bf16 v[112:127], v[20:23], a[248:251], v[112:127]
    v_mul_f32 v37, v37, v133
    v_mul_f32 v38, v38, v134
    v_mul_f32 v39, v39, v135
    v_cvt_pk_bf16_f32 v136, -v32, -v33
    v_cvt_pk_bf16_f32 v137, -v34, -v35
    v_cvt_pk_bf16_f32 v138, -v36, -v37
    v_cvt_pk_bf16_f32 v139, -v38, -v39
    ds_write_b128 v7, v[136:139] offset:0
    v_exp_f32 v128, -abs(v48)
    v_exp_f32 v56, v56
    s_waitcnt vmcnt(4)
    ds_read2st64_b32 v[28:29], v4 offset0:44 offset1:45
    ds_read2st64_b32 v[30:31], v4 offset0:46 offset1:47
    s_add_u32 s38, s38, 1024
    buffer_load_dwordx4 v5, s[12:15], s38 offen offset:3072 sc1 lds
    v_exp_f32 v129, -abs(v49)
    v_exp_f32 v57, v57
    v_exp_f32 v130, -abs(v50)
    v_exp_f32 v58, v58
    v_exp_f32 v131, -abs(v51)
    v_exp_f32 v59, v59
    s_waitcnt lgkmcnt(2)
    v_mfma_f32_32x32x16_bf16 v[80:95], v[24:27], a[188:191], v[80:95]
    v_exp_f32 v132, -abs(v52)
    v_exp_f32 v60, v60
    v_exp_f32 v133, -abs(v53)
    v_exp_f32 v61, v61
    v_exp_f32 v134, -abs(v54)
    v_exp_f32 v62, v62
    v_mfma_f32_32x32x16_bf16 v[96:111], v[24:27], a[220:223], v[96:111]
    v_exp_f32 v135, -abs(v55)
    v_exp_f32 v63, v63
    v_fma_f32 v128, v128, v128, 1.0
    v_fma_f32 v129, v129, v129, 1.0
    v_fma_f32 v130, v130, v130, 1.0
    v_fma_f32 v131, v131, v131, 1.0
    v_fma_f32 v132, v132, v132, 1.0
    v_fma_f32 v133, v133, v133, 1.0
    v_fma_f32 v134, v134, v134, 1.0
    v_fma_f32 v135, v135, v135, 1.0
    v_mfma_f32_32x32x16_bf16 v[112:127], v[24:27], a[252:255], v[112:127]
    v_sub_f32 v144, 2.0, v128
    v_fmac_f32 v128, v56, v128
    v_sub_f32 v145, 2.0, v129
    v_fmac_f32 v129, v57, v129
    v_sub_f32 v146, 2.0, v130
    v_fmac_f32 v130, v58, v130
    v_sub_f32 v147, 2.0, v131
    v_fmac_f32 v131, v59, v131
    v_sub_f32 v148, 2.0, v132
    v_fmac_f32 v132, v60, v132
    v_sub_f32 v149, 2.0, v133
    v_fmac_f32 v133, v61, v133
    s_waitcnt vmcnt(4)
    ds_read2st64_b32 v[16:17], v4 offset0:48 offset1:49
    ds_read2st64_b32 v[18:19], v4 offset0:50 offset1:51
    s_waitcnt vmcnt(2)
L_spin_y2:
    v_cmp_ne_u32 vcc, s27, v155
    s_add_u32 s67, s67, 1
    s_cmp_ge_u32 s67, 120000
    s_cbranch_scc1 L_go_y2
    s_cbranch_vccz L_go_y2
    s_sleep 2
    buffer_load_dword v155, v13, s[12:15], 0 offen sc1
    s_waitcnt vmcnt(0)
    s_branch L_spin_y2
L_go_y2:
    s_barrier
    v_add_u32 v13, 32768, v13
    s_add_u32 m0, s39, 16384
    s_add_u32 s38, s38, 4174848
    buffer_load_dwordx4 v5, s[12:15], s38 offen offset:0 sc1 lds
    v_sub_f32 v150, 2.0, v134
    v_fmac_f32 v134, v62, v134
    v_sub_f32 v151, 2.0, v135
    v_fmac_f32 v135, v63, v135
    v_rcp_f32 v128, v128
    v_bfi_b32 v48, s33, v144, v48
    v_rcp_f32 v129, v129
    v_bfi_b32 v49, s33, v145, v49
    v_rcp_f32 v130, v130
    s_waitcnt lgkmcnt(2)
    v_mfma_f32_32x32x16_bf16 v[80:95], v[28:31], a[192:195], v[80:95]
    v_bfi_b32 v50, s33, v146, v50
    v_rcp_f32 v131, v131
    v_bfi_b32 v51, s33, v147, v51
    v_rcp_f32 v132, v132
    v_bfi_b32 v52, s33, v148, v52
    v_rcp_f32 v133, v133
    v_bfi_b32 v53, s33, v149, v53
    v_rcp_f32 v134, v134
    v_mfma_f32_32x32x16_bf16 v[96:111], v[28:31], a[224:227], v[96:111]
    v_bfi_b32 v54, s33, v150, v54
    v_rcp_f32 v135, v135
    v_bfi_b32 v55, s33, v151, v55
    v_mul_f32 v48, v48, v128
    v_mul_f32 v49, v49, v129
    v_mul_f32 v50, v50, v130
    v_mul_f32 v51, v51, v131
    v_mul_f32 v52, v52, v132
    v_mul_f32 v53, v53, v133
    v_mul_f32 v54, v54, v134
    v_mul_f32 v55, v55, v135
    v_mfma_f32_32x32x16_bf16 v[112:127], v[28:31], v[236:239], v[112:127]
    v_cvt_pk_bf16_f32 v140, -v48, -v49
    v_cvt_pk_bf16_f32 v141, -v50, -v51
    v_cvt_pk_bf16_f32 v142, -v52, -v53
    v_cvt_pk_bf16_f32 v143, -v54, -v55
    ds_write_b128 v7, v[140:143] offset:4096
    v_exp_f32 v128, -abs(v64)
    v_exp_f32 v72, v72
    v_exp_f32 v129, -abs(v65)
    v_exp_f32 v73, v73
    s_waitcnt vmcnt(4)
    ds_read2st64_b32 v[20:21], v4 offset0:52 offset1:53
    ds_read2st64_b32 v[22:23], v4 offset0:54 offset1:55
    s_add_u32 s38, s38, 1024
    buffer_load_dwordx4 v5, s[12:15], s38 offen offset:1024 sc1 lds
    v_exp_f32 v130, -abs(v66)
    v_exp_f32 v74, v74
    v_exp_f32 v131, -abs(v67)
    v_exp_f32 v75, v75
    v_exp_f32 v132, -abs(v68)
    v_exp_f32 v76, v76
    s_waitcnt lgkmcnt(2)
    v_mfma_f32_32x32x16_bf16 v[80:95], v[16:19], a[196:199], v[80:95]
    v_exp_f32 v133, -abs(v69)
    v_exp_f32 v77, v77
    v_exp_f32 v134, -abs(v70)
    v_exp_f32 v78, v78
    v_exp_f32 v135, -abs(v71)
    v_exp_f32 v79, v79
    v_mfma_f32_32x32x16_bf16 v[96:111], v[16:19], a[228:231], v[96:111]
    v_fma_f32 v128, v128, v128, 1.0
    v_fma_f32 v129, v129, v129, 1.0
    v_fma_f32 v130, v130, v130, 1.0
    v_fma_f32 v131, v131, v131, 1.0
    v_fma_f32 v132, v132, v132, 1.0
    v_fma_f32 v133, v133, v133, 1.0
    v_fma_f32 v134, v134, v134, 1.0
    v_fma_f32 v135, v135, v135, 1.0
    v_sub_f32 v144, 2.0, v128
    v_fmac_f32 v128, v72, v128
    v_sub_f32 v145, 2.0, v129
    v_fmac_f32 v129, v73, v129
    v_mfma_f32_32x32x16_bf16 v[112:127], v[16:19], v[240:243], v[112:127]
    v_sub_f32 v146, 2.0, v130
    v_fmac_f32 v130, v74, v130
    v_sub_f32 v147, 2.0, v131
    v_fmac_f32 v131, v75, v131
    v_sub_f32 v148, 2.0, v132
    v_fmac_f32 v132, v76, v132
    v_sub_f32 v149, 2.0, v133
    v_fmac_f32 v133, v77, v133
    v_sub_f32 v150, 2.0, v134
    v_fmac_f32 v134, v78, v134
    v_sub_f32 v151, 2.0, v135
    v_fmac_f32 v135, v79, v135
    s_waitcnt vmcnt(3)
    ds_read2st64_b32 v[24:25], v4 offset0:56 offset1:57
    ds_read2st64_b32 v[26:27], v4 offset0:58 offset1:59
    s_add_u32 s38, s38, 1024
    buffer_load_dwordx4 v5, s[12:15], s38 offen offset:2048 sc1 lds
    v_rcp_f32 v128, v128
    v_bfi_b32 v64, s33, v144, v64
    v_rcp_f32 v129, v129
    v_bfi_b32 v65, s33, v145, v65
    v_rcp_f32 v130, v130
    v_bfi_b32 v66, s33, v146, v66
    v_rcp_f32 v131, v131
    v_bfi_b32 v67, s33, v147, v67
    s_waitcnt lgkmcnt(2)
    v_mfma_f32_32x32x16_bf16 v[80:95], v[20:23], a[200:203], v[80:95]
    v_rcp_f32 v132, v132
    v_bfi_b32 v68, s33, v148, v68
    v_rcp_f32 v133, v133
    v_bfi_b32 v69, s33, v149, v69
    v_rcp_f32 v134, v134
    v_bfi_b32 v70, s33, v150, v70
    v_rcp_f32 v135, v135
    v_bfi_b32 v71, s33, v151, v71
    v_mfma_f32_32x32x16_bf16 v[96:111], v[20:23], a[232:235], v[96:111]
    v_mul_f32 v64, v64, v128
    v_mul_f32 v65, v65, v129
    v_mul_f32 v66, v66, v130
    v_mul_f32 v67, v67, v131
    v_mul_f32 v68, v68, v132
    v_mul_f32 v69, v69, v133
    v_mul_f32 v70, v70, v134
    v_mul_f32 v71, v71, v135
    v_cvt_pk_bf16_f32 v136, -v64, -v65
    v_cvt_pk_bf16_f32 v137, -v66, -v67
    v_cvt_pk_bf16_f32 v138, -v68, -v69
    v_cvt_pk_bf16_f32 v139, -v70, -v71
    v_mfma_f32_32x32x16_bf16 v[112:127], v[20:23], v[244:247], v[112:127]
    ds_write_b128 v7, v[136:139] offset:8192
    s_waitcnt vmcnt(3)
    ds_read2st64_b32 v[28:29], v4 offset0:60 offset1:61
    ds_read2st64_b32 v[30:31], v4 offset0:62 offset1:63
    s_add_u32 s38, s38, 1024
    buffer_load_dwordx4 v5, s[12:15], s38 offen offset:3072 sc1 lds
    s_waitcnt lgkmcnt(2)
    v_mfma_f32_32x32x16_bf16 v[80:95], v[24:27], a[204:207], v[80:95]
    v_mfma_f32_32x32x16_bf16 v[96:111], v[24:27], a[236:239], v[96:111]
    v_mfma_f32_32x32x16_bf16 v[112:127], v[24:27], v[248:251], v[112:127]
    s_waitcnt vmcnt(3)
    ds_read2st64_b32 v[16:17], v4 offset0:64 offset1:65
    ds_read2st64_b32 v[18:19], v4 offset0:66 offset1:67
    s_add_u32 m0, s39, 20480
    s_add_u32 s38, s38, 13312
    buffer_load_dwordx4 v5, s[12:15], s38 offen offset:0 sc1 lds
    s_waitcnt lgkmcnt(2)
    v_mfma_f32_32x32x16_bf16 v[80:95], v[28:31], a[208:211], v[80:95]
    v_mfma_f32_32x32x16_bf16 v[96:111], v[28:31], a[240:243], v[96:111]
    v_mfma_f32_32x32x16_bf16 v[112:127], v[28:31], v[252:255], v[112:127]
    s_waitcnt vmcnt(3)
    ds_read2st64_b32 v[20:21], v4 offset0:68 offset1:69
    ds_read2st64_b32 v[22:23], v4 offset0:70 offset1:71
    s_add_u32 s38, s38, 1024
    buffer_load_dwordx4 v5, s[12:15], s38 offen offset:1024 sc1 lds
    s_nop 9
    v_exp_f32 v128, -abs(v80)
    v_exp_f32 v88, v88
    v_exp_f32 v129, -abs(v81)
    v_exp_f32 v89, v89
    v_exp_f32 v130, -abs(v82)
    v_exp_f32 v90, v90
    s_waitcnt lgkmcnt(2)
    v_mfma_f32_32x32x16_bf16 v[32:47], v[16:19], a[180:183], 0
    s_waitcnt lgkmcnt(0)
    s_barrier
    ds_read_b128 v[160:163], v8 offset:0
    ds_read_b128 v[164:167], v8 offset:4096
    ds_read_b128 v[168:171], v8 offset:8192
    v_exp_f32 v131, -abs(v83)
    v_exp_f32 v91, v91
    v_exp_f32 v132, -abs(v84)
    v_exp_f32 v92, v92
    v_mfma_f32_32x32x16_bf16 v[48:63], v[16:19], a[212:215], 0
    v_exp_f32 v133, -abs(v85)
    v_exp_f32 v93, v93
    v_exp_f32 v134, -abs(v86)
    v_exp_f32 v94, v94
    s_waitcnt lgkmcnt(0)
    buffer_store_dwordx4 v[160:163], v6, s[16:19], 0 offen sc1
    v_add_u32 v6, 18432, v6
    v_exp_f32 v135, -abs(v87)
    v_mfma_f32_32x32x16_bf16 v[64:79], v[16:19], a[244:247], 0
    v_exp_f32 v95, v95
    v_fma_f32 v128, v128, v128, 1.0
    v_fma_f32 v129, v129, v129, 1.0
    v_fma_f32 v130, v130, v130, 1.0
    v_fma_f32 v131, v131, v131, 1.0
    v_fma_f32 v132, v132, v132, 1.0
    v_fma_f32 v133, v133, v133, 1.0
    buffer_store_dwordx4 v[164:167], v6, s[16:19], 0 offen sc1
    v_add_u32 v6, 18432, v6
    v_fma_f32 v134, v134, v134, 1.0
    v_fma_f32 v135, v135, v135, 1.0
    s_waitcnt vmcnt(5)
    ds_read2st64_b32 v[24:25], v4 offset0:72 offset1:73
    ds_read2st64_b32 v[26:27], v4 offset0:74 offset1:75
    s_add_u32 s38, s38, 1024
    buffer_load_dwordx4 v5, s[12:15], s38 offen offset:2048 sc1 lds
    v_sub_f32 v144, 2.0, v128
    v_fmac_f32 v128, v88, v128
    v_sub_f32 v145, 2.0, v129
    v_fmac_f32 v129, v89, v129
    v_sub_f32 v146, 2.0, v130
    v_fmac_f32 v130, v90, v130
    buffer_store_dwordx4 v[168:171], v6, s[16:19], 0 offen sc1
    v_add_u32 v6, 737280, v6
    v_sub_f32 v147, 2.0, v131
    v_fmac_f32 v131, v91, v131
    v_sub_f32 v148, 2.0, v132
    v_fmac_f32 v132, v92, v132
    s_waitcnt lgkmcnt(2)
    v_mfma_f32_32x32x16_bf16 v[32:47], v[20:23], a[184:187], v[32:47]
    v_sub_f32 v149, 2.0, v133
    v_fmac_f32 v133, v93, v133
    v_sub_f32 v150, 2.0, v134
    v_fmac_f32 v134, v94, v134
    v_sub_f32 v151, 2.0, v135
    v_fmac_f32 v135, v95, v135
    v_rcp_f32 v128, v128
    v_bfi_b32 v80, s33, v144, v80
    v_rcp_f32 v129, v129
    v_bfi_b32 v81, s33, v145, v81
    v_mfma_f32_32x32x16_bf16 v[48:63], v[20:23], a[216:219], v[48:63]
    v_rcp_f32 v130, v130
    v_bfi_b32 v82, s33, v146, v82
    v_rcp_f32 v131, v131
    v_bfi_b32 v83, s33, v147, v83
    v_rcp_f32 v132, v132
    v_bfi_b32 v84, s33, v148, v84
    v_rcp_f32 v133, v133
    v_bfi_b32 v85, s33, v149, v85
    v_mfma_f32_32x32x16_bf16 v[64:79], v[20:23], a[248:251], v[64:79]
    v_rcp_f32 v134, v134
    v_bfi_b32 v86, s33, v150, v86
    v_rcp_f32 v135, v135
    v_bfi_b32 v87, s33, v151, v87
    v_mul_f32 v80, v80, v128
    v_mul_f32 v81, v81, v129
    v_mul_f32 v82, v82, v130
    v_mul_f32 v83, v83, v131
    v_mul_f32 v84, v84, v132
    v_mul_f32 v85, v85, v133
    s_waitcnt vmcnt(6)
    ds_read2st64_b32 v[28:29], v4 offset0:76 offset1:77
    ds_read2st64_b32 v[30:31], v4 offset0:78 offset1:79
    s_add_u32 s38, s38, 1024
    buffer_load_dwordx4 v5, s[12:15], s38 offen offset:3072 sc1 lds
    v_mul_f32 v86, v86, v134
    v_mul_f32 v87, v87, v135
    v_cvt_pk_bf16_f32 v140, -v80, -v81
    v_cvt_pk_bf16_f32 v141, -v82, -v83
    v_cvt_pk_bf16_f32 v142, -v84, -v85
    v_cvt_pk_bf16_f32 v143, -v86, -v87
    ds_write_b128 v7, v[140:143] offset:12288
    v_exp_f32 v128, -abs(v96)
    v_exp_f32 v104, v104
    v_exp_f32 v129, -abs(v97)
    s_waitcnt lgkmcnt(3)
    v_mfma_f32_32x32x16_bf16 v[32:47], v[24:27], a[188:191], v[32:47]
    v_exp_f32 v105, v105
    v_exp_f32 v130, -abs(v98)
    v_exp_f32 v106, v106
    v_exp_f32 v131, -abs(v99)
    v_exp_f32 v107, v107
    v_exp_f32 v132, -abs(v100)
    v_mfma_f32_32x32x16_bf16 v[48:63], v[24:27], a[220:223], v[48:63]
    v_exp_f32 v108, v108
    v_exp_f32 v133, -abs(v101)
    v_exp_f32 v109, v109
    v_exp_f32 v134, -abs(v102)
    v_exp_f32 v110, v110
    v_exp_f32 v135, -abs(v103)
    v_mfma_f32_32x32x16_bf16 v[64:79], v[24:27], a[252:255], v[64:79]
    v_exp_f32 v111, v111
    v_fma_f32 v128, v128, v128, 1.0
    v_fma_f32 v129, v129, v129, 1.0
    v_fma_f32 v130, v130, v130, 1.0
    v_fma_f32 v131, v131, v131, 1.0
    v_fma_f32 v132, v132, v132, 1.0
    v_fma_f32 v133, v133, v133, 1.0
    v_fma_f32 v134, v134, v134, 1.0
    v_fma_f32 v135, v135, v135, 1.0
    v_sub_f32 v144, 2.0, v128
    v_fmac_f32 v128, v104, v128
    s_waitcnt vmcnt(6)
    ds_read2st64_b32 v[16:17], v4 offset0:80 offset1:81
    ds_read2st64_b32 v[18:19], v4 offset0:82 offset1:83
    v_sub_f32 v145, 2.0, v129
    v_fmac_f32 v129, v105, v129
    v_sub_f32 v146, 2.0, v130
    v_fmac_f32 v130, v106, v130
    v_sub_f32 v147, 2.0, v131
    v_fmac_f32 v131, v107, v131
    v_sub_f32 v148, 2.0, v132
    v_fmac_f32 v132, v108, v132
    v_sub_f32 v149, 2.0, v133
    v_fmac_f32 v133, v109, v133
    v_sub_f32 v150, 2.0, v134
    v_fmac_f32 v134, v110, v134
    s_waitcnt lgkmcnt(2)
    v_mfma_f32_32x32x16_bf16 v[32:47], v[28:31], a[192:195], v[32:47]
    v_sub_f32 v151, 2.0, v135
    v_fmac_f32 v135, v111, v135
    v_rcp_f32 v128, v128
    v_bfi_b32 v96, s33, v144, v96
    v_rcp_f32 v129, v129
    v_bfi_b32 v97, s33, v145, v97
    v_rcp_f32 v130, v130
    v_bfi_b32 v98, s33, v146, v98
    v_rcp_f32 v131, v131
    v_mfma_f32_32x32x16_bf16 v[48:63], v[28:31], a[224:227], v[48:63]
    v_bfi_b32 v99, s33, v147, v99
    v_rcp_f32 v132, v132
    v_bfi_b32 v100, s33, v148, v100
    v_rcp_f32 v133, v133
    v_bfi_b32 v101, s33, v149, v101
    v_rcp_f32 v134, v134
    v_bfi_b32 v102, s33, v150, v102
    v_rcp_f32 v135, v135
    v_mfma_f32_32x32x16_bf16 v[64:79], v[28:31], v[236:239], v[64:79]
    v_bfi_b32 v103, s33, v151, v103
    v_mul_f32 v96, v96, v128
    v_mul_f32 v97, v97, v129
    v_mul_f32 v98, v98, v130
    v_mul_f32 v99, v99, v131
    v_mul_f32 v100, v100, v132
    v_mul_f32 v101, v101, v133
    v_mul_f32 v102, v102, v134
    v_mul_f32 v103, v103, v135
    v_cvt_pk_bf16_f32 v136, -v96, -v97
    v_cvt_pk_bf16_f32 v137, -v98, -v99
    v_cvt_pk_bf16_f32 v138, -v100, -v101
    s_waitcnt vmcnt(5)
    ds_read2st64_b32 v[20:21], v4 offset0:84 offset1:85
    ds_read2st64_b32 v[22:23], v4 offset0:86 offset1:87
    v_cvt_pk_bf16_f32 v139, -v102, -v103
    ds_write_b128 v7, v[136:139] offset:16384
    v_exp_f32 v128, -abs(v112)
    v_exp_f32 v120, v120
    v_exp_f32 v129, -abs(v113)
    v_exp_f32 v121, v121
    v_exp_f32 v130, -abs(v114)
    s_waitcnt lgkmcnt(3)
    v_mfma_f32_32x32x16_bf16 v[32:47], v[16:19], a[196:199], v[32:47]
    v_exp_f32 v122, v122
    v_exp_f32 v131, -abs(v115)
    v_exp_f32 v123, v123
    v_exp_f32 v132, -abs(v116)
    v_exp_f32 v124, v124
    v_exp_f32 v133, -abs(v117)
    v_mfma_f32_32x32x16_bf16 v[48:63], v[16:19], a[228:231], v[48:63]
    v_exp_f32 v125, v125
    v_exp_f32 v134, -abs(v118)
    v_exp_f32 v126, v126
    v_exp_f32 v135, -abs(v119)
    v_exp_f32 v127, v127
    v_fma_f32 v128, v128, v128, 1.0
    v_fma_f32 v129, v129, v129, 1.0
    v_mfma_f32_32x32x16_bf16 v[64:79], v[16:19], v[240:243], v[64:79]
    v_fma_f32 v130, v130, v130, 1.0
    v_fma_f32 v131, v131, v131, 1.0
    v_fma_f32 v132, v132, v132, 1.0
    v_fma_f32 v133, v133, v133, 1.0
    v_fma_f32 v134, v134, v134, 1.0
    v_fma_f32 v135, v135, v135, 1.0
    v_sub_f32 v144, 2.0, v128
    v_fmac_f32 v128, v120, v128
    v_sub_f32 v145, 2.0, v129
    v_fmac_f32 v129, v121, v129
    v_sub_f32 v146, 2.0, v130
    v_fmac_f32 v130, v122, v130
    s_waitcnt vmcnt(2)
    ds_read2st64_b32 v[24:25], v4 offset0:88 offset1:89
    ds_read2st64_b32 v[26:27], v4 offset0:90 offset1:91
    v_sub_f32 v147, 2.0, v131
    v_fmac_f32 v131, v123, v131
    v_sub_f32 v148, 2.0, v132
    v_fmac_f32 v132, v124, v132
    v_sub_f32 v149, 2.0, v133
    v_fmac_f32 v133, v125, v133
    v_sub_f32 v150, 2.0, v134
    v_fmac_f32 v134, v126, v134
    v_sub_f32 v151, 2.0, v135
    v_fmac_f32 v135, v127, v135
    v_rcp_f32 v128, v128
    s_waitcnt lgkmcnt(2)
    v_mfma_f32_32x32x16_bf16 v[32:47], v[20:23], a[200:203], v[32:47]
    v_bfi_b32 v112, s33, v144, v112
    v_rcp_f32 v129, v129
    v_bfi_b32 v113, s33, v145, v113
    v_rcp_f32 v130, v130
    v_bfi_b32 v114, s33, v146, v114
    v_rcp_f32 v131, v131
    v_bfi_b32 v115, s33, v147, v115
    v_rcp_f32 v132, v132
    v_mfma_f32_32x32x16_bf16 v[48:63], v[20:23], a[232:235], v[48:63]
    v_bfi_b32 v116, s33, v148, v116
    v_rcp_f32 v133, v133
    v_bfi_b32 v117, s33, v149, v117
    v_rcp_f32 v134, v134
    v_bfi_b32 v118, s33, v150, v118
    v_rcp_f32 v135, v135
    v_bfi_b32 v119, s33, v151, v119
    v_mul_f32 v112, v112, v128
    v_mul_f32 v113, v113, v129
    v_mfma_f32_32x32x16_bf16 v[64:79], v[20:23], v[244:247], v[64:79]
    v_mul_f32 v114, v114, v130
    v_mul_f32 v115, v115, v131
    v_mul_f32 v116, v116, v132
    v_mul_f32 v117, v117, v133
    v_mul_f32 v118, v118, v134
    v_mul_f32 v119, v119, v135
    v_cvt_pk_bf16_f32 v140, -v112, -v113
    v_cvt_pk_bf16_f32 v141, -v114, -v115
    v_cvt_pk_bf16_f32 v142, -v116, -v117
    v_cvt_pk_bf16_f32 v143, -v118, -v119
    ds_write_b128 v7, v[140:143] offset:20480
    s_waitcnt vmcnt(0)
    ds_read2st64_b32 v[28:29], v4 offset0:92 offset1:93
    ds_read2st64_b32 v[30:31], v4 offset0:94 offset1:95
    s_waitcnt lgkmcnt(2)
    v_mfma_f32_32x32x16_bf16 v[32:47], v[24:27], a[204:207], v[32:47]
    v_mfma_f32_32x32x16_bf16 v[48:63], v[24:27], a[236:239], v[48:63]
    v_mfma_f32_32x32x16_bf16 v[64:79], v[24:27], v[248:251], v[64:79]
    s_waitcnt lgkmcnt(0)
    v_mfma_f32_32x32x16_bf16 v[32:47], v[28:31], a[208:211], v[32:47]
    v_mfma_f32_32x32x16_bf16 v[48:63], v[28:31], a[240:243], v[48:63]
    v_mfma_f32_32x32x16_bf16 v[64:79], v[28:31], v[252:255], v[64:79]
    s_nop 9
    v_exp_f32 v128, -abs(v32)
    v_exp_f32 v40, v40
    v_exp_f32 v129, -abs(v33)
    v_exp_f32 v41, v41
    v_exp_f32 v130, -abs(v34)
    v_exp_f32 v42, v42
    s_waitcnt lgkmcnt(0)
    s_barrier
    ds_read_b128 v[172:175], v8 offset:12288
    ds_read_b128 v[176:179], v8 offset:16384
    ds_read_b128 v[180:183], v8 offset:20480
    v_exp_f32 v131, -abs(v35)
    v_exp_f32 v43, v43
    v_exp_f32 v132, -abs(v36)
    v_exp_f32 v44, v44
    v_exp_f32 v133, -abs(v37)
    v_exp_f32 v45, v45
    v_exp_f32 v134, -abs(v38)
    v_exp_f32 v46, v46
    s_waitcnt lgkmcnt(0)
    buffer_store_dwordx4 v[172:175], v6, s[16:19], 0 offen sc1
    v_add_u32 v6, 18432, v6
    v_exp_f32 v135, -abs(v39)
    v_exp_f32 v47, v47
    v_pk_fma_f32 v[128:129], v[128:129], v[128:129], 1.0 op_sel_hi:[1,1,0]
    v_pk_fma_f32 v[130:131], v[130:131], v[130:131], 1.0 op_sel_hi:[1,1,0]
    v_pk_fma_f32 v[132:133], v[132:133], v[132:133], 1.0 op_sel_hi:[1,1,0]
    v_pk_fma_f32 v[134:135], v[134:135], v[134:135], 1.0 op_sel_hi:[1,1,0]
    v_pk_fma_f32 v[40:41], v[40:41], v[128:129], v[128:129]
    v_pk_fma_f32 v[42:43], v[42:43], v[130:131], v[130:131]
    buffer_store_dwordx4 v[176:179], v6, s[16:19], 0 offen sc1
    v_add_u32 v6, 18432, v6
    v_pk_fma_f32 v[44:45], v[44:45], v[132:133], v[132:133]
    v_pk_fma_f32 v[46:47], v[46:47], v[134:135], v[134:135]
    v_rcp_f32 v40, v40
    v_rcp_f32 v41, v41
    v_pk_add_f32 v[128:129], 2.0, v[128:129] op_sel_hi:[0,1] neg_lo:[0,1] neg_hi:[0,1]
    v_rcp_f32 v42, v42
    v_rcp_f32 v43, v43
    v_pk_add_f32 v[130:131], 2.0, v[130:131] op_sel_hi:[0,1] neg_lo:[0,1] neg_hi:[0,1]
    buffer_store_dwordx4 v[180:183], v6, s[16:19], 0 offen sc1
    v_add_u32 v6, 737280, v6
    v_rcp_f32 v44, v44
    v_rcp_f32 v45, v45
    v_pk_add_f32 v[132:133], 2.0, v[132:133] op_sel_hi:[0,1] neg_lo:[0,1] neg_hi:[0,1]
    v_rcp_f32 v46, v46
    v_rcp_f32 v47, v47
    v_pk_add_f32 v[134:135], 2.0, v[134:135] op_sel_hi:[0,1] neg_lo:[0,1] neg_hi:[0,1]
    v_bfi_b32 v32, s33, v128, v32
    v_bfi_b32 v33, s33, v129, v33
    v_bfi_b32 v34, s33, v130, v34
    v_bfi_b32 v35, s33, v131, v35
    v_bfi_b32 v36, s33, v132, v36
    v_bfi_b32 v37, s33, v133, v37
    v_bfi_b32 v38, s33, v134, v38
    v_bfi_b32 v39, s33, v135, v39
    v_pk_mul_f32 v[32:33], v[32:33], v[40:41]
    v_pk_mul_f32 v[34:35], v[34:35], v[42:43]
    v_pk_mul_f32 v[36:37], v[36:37], v[44:45]
    v_pk_mul_f32 v[38:39], v[38:39], v[46:47]
    v_cvt_pk_bf16_f32 v136, -v32, -v33
    v_cvt_pk_bf16_f32 v137, -v34, -v35
    v_cvt_pk_bf16_f32 v138, -v36, -v37
    v_cvt_pk_bf16_f32 v139, -v38, -v39
    ds_write_b128 v7, v[136:139] offset:24576
    v_exp_f32 v128, -abs(v48)
    v_exp_f32 v56, v56
    v_exp_f32 v129, -abs(v49)
    v_exp_f32 v57, v57
    v_exp_f32 v130, -abs(v50)
    v_exp_f32 v58, v58
    s_waitcnt lgkmcnt(0)
    s_barrier
    ds_read_b128 v[184:187], v8 offset:24576
    v_exp_f32 v131, -abs(v51)
    v_exp_f32 v59, v59
    v_exp_f32 v132, -abs(v52)
    v_exp_f32 v60, v60
    v_exp_f32 v133, -abs(v53)
    v_exp_f32 v61, v61
    v_exp_f32 v134, -abs(v54)
    v_exp_f32 v62, v62
    s_waitcnt lgkmcnt(0)
    buffer_store_dwordx4 v[184:187], v6, s[16:19], 0 offen sc1
    v_add_u32 v6, 18432, v6
    v_exp_f32 v135, -abs(v55)
    v_exp_f32 v63, v63
    v_pk_fma_f32 v[128:129], v[128:129], v[128:129], 1.0 op_sel_hi:[1,1,0]
    v_pk_fma_f32 v[130:131], v[130:131], v[130:131], 1.0 op_sel_hi:[1,1,0]
    v_pk_fma_f32 v[132:133], v[132:133], v[132:133], 1.0 op_sel_hi:[1,1,0]
    v_pk_fma_f32 v[134:135], v[134:135], v[134:135], 1.0 op_sel_hi:[1,1,0]
    v_pk_fma_f32 v[56:57], v[56:57], v[128:129], v[128:129]
    v_pk_fma_f32 v[58:59], v[58:59], v[130:131], v[130:131]
    v_pk_fma_f32 v[60:61], v[60:61], v[132:133], v[132:133]
    v_pk_fma_f32 v[62:63], v[62:63], v[134:135], v[134:135]
    v_rcp_f32 v56, v56
    v_rcp_f32 v57, v57
    v_pk_add_f32 v[128:129], 2.0, v[128:129] op_sel_hi:[0,1] neg_lo:[0,1] neg_hi:[0,1]
    v_rcp_f32 v58, v58
    v_rcp_f32 v59, v59
    v_pk_add_f32 v[130:131], 2.0, v[130:131] op_sel_hi:[0,1] neg_lo:[0,1] neg_hi:[0,1]
    v_rcp_f32 v60, v60
    v_rcp_f32 v61, v61
    v_pk_add_f32 v[132:133], 2.0, v[132:133] op_sel_hi:[0,1] neg_lo:[0,1] neg_hi:[0,1]
    v_rcp_f32 v62, v62
    v_rcp_f32 v63, v63
    v_pk_add_f32 v[134:135], 2.0, v[134:135] op_sel_hi:[0,1] neg_lo:[0,1] neg_hi:[0,1]
    v_bfi_b32 v48, s33, v128, v48
    v_bfi_b32 v49, s33, v129, v49
    v_bfi_b32 v50, s33, v130, v50
    v_bfi_b32 v51, s33, v131, v51
    v_bfi_b32 v52, s33, v132, v52
    v_bfi_b32 v53, s33, v133, v53
    v_bfi_b32 v54, s33, v134, v54
    v_bfi_b32 v55, s33, v135, v55
    v_pk_mul_f32 v[48:49], v[48:49], v[56:57]
    v_pk_mul_f32 v[50:51], v[50:51], v[58:59]
    v_pk_mul_f32 v[52:53], v[52:53], v[60:61]
    v_pk_mul_f32 v[54:55], v[54:55], v[62:63]
    v_cvt_pk_bf16_f32 v140, -v48, -v49
    v_cvt_pk_bf16_f32 v141, -v50, -v51
    v_cvt_pk_bf16_f32 v142, -v52, -v53
    v_cvt_pk_bf16_f32 v143, -v54, -v55
    ds_write_b128 v7, v[140:143] offset:28672
    v_exp_f32 v128, -abs(v64)
    v_exp_f32 v72, v72
    v_exp_f32 v129, -abs(v65)
    v_exp_f32 v73, v73
    v_exp_f32 v130, -abs(v66)
    v_exp_f32 v74, v74
    s_waitcnt lgkmcnt(0)
    s_barrier
    ds_read_b128 v[188:191], v8 offset:28672
    v_exp_f32 v131, -abs(v67)
    v_exp_f32 v75, v75
    v_exp_f32 v132, -abs(v68)
    v_exp_f32 v76, v76
    v_exp_f32 v133, -abs(v69)
    v_exp_f32 v77, v77
    v_exp_f32 v134, -abs(v70)
    v_exp_f32 v78, v78
    s_waitcnt lgkmcnt(0)
    buffer_store_dwordx4 v[188:191], v6, s[16:19], 0 offen sc1
    v_add_u32 v6, 18432, v6
    v_exp_f32 v135, -abs(v71)
    v_exp_f32 v79, v79
    v_pk_fma_f32 v[128:129], v[128:129], v[128:129], 1.0 op_sel_hi:[1,1,0]
    v_pk_fma_f32 v[130:131], v[130:131], v[130:131], 1.0 op_sel_hi:[1,1,0]
    v_pk_fma_f32 v[132:133], v[132:133], v[132:133], 1.0 op_sel_hi:[1,1,0]
    v_pk_fma_f32 v[134:135], v[134:135], v[134:135], 1.0 op_sel_hi:[1,1,0]
    v_pk_fma_f32 v[72:73], v[72:73], v[128:129], v[128:129]
    v_pk_fma_f32 v[74:75], v[74:75], v[130:131], v[130:131]
    v_pk_fma_f32 v[76:77], v[76:77], v[132:133], v[132:133]
    v_pk_fma_f32 v[78:79], v[78:79], v[134:135], v[134:135]
    v_rcp_f32 v72, v72
    v_rcp_f32 v73, v73
    v_pk_add_f32 v[128:129], 2.0, v[128:129] op_sel_hi:[0,1] neg_lo:[0,1] neg_hi:[0,1]
    v_rcp_f32 v74, v74
    v_rcp_f32 v75, v75
    v_pk_add_f32 v[130:131], 2.0, v[130:131] op_sel_hi:[0,1] neg_lo:[0,1] neg_hi:[0,1]
    v_rcp_f32 v76, v76
    v_rcp_f32 v77, v77
    v_pk_add_f32 v[132:133], 2.0, v[132:133] op_sel_hi:[0,1] neg_lo:[0,1] neg_hi:[0,1]
    v_rcp_f32 v78, v78
    v_rcp_f32 v79, v79
    v_pk_add_f32 v[134:135], 2.0, v[134:135] op_sel_hi:[0,1] neg_lo:[0,1] neg_hi:[0,1]
    v_bfi_b32 v64, s33, v128, v64
    v_bfi_b32 v65, s33, v129, v65
    v_bfi_b32 v66, s33, v130, v66
    v_bfi_b32 v67, s33, v131, v67
    v_bfi_b32 v68, s33, v132, v68
    v_bfi_b32 v69, s33, v133, v69
    v_bfi_b32 v70, s33, v134, v70
    v_bfi_b32 v71, s33, v135, v71
    v_pk_mul_f32 v[64:65], v[64:65], v[72:73]
    v_pk_mul_f32 v[66:67], v[66:67], v[74:75]
    v_pk_mul_f32 v[68:69], v[68:69], v[76:77]
    v_pk_mul_f32 v[70:71], v[70:71], v[78:79]
    v_cvt_pk_bf16_f32 v136, -v64, -v65
    v_cvt_pk_bf16_f32 v137, -v66, -v67
    v_cvt_pk_bf16_f32 v138, -v68, -v69
    v_cvt_pk_bf16_f32 v139, -v70, -v71
    ds_write_b128 v7, v[136:139] offset:32768
    s_waitcnt lgkmcnt(0)
    s_barrier
    ds_read_b128 v[192:195], v8 offset:32768
    s_waitcnt lgkmcnt(0)
    buffer_store_dwordx4 v[192:195], v6, s[16:19], 0 offen sc1
    v_add_u32 v6, 737280, v6
L_fin:
L_end_standalone__autoregressive_conv_wavernn__speech_kernel:
    s_endpgm
.section .rodata,"a"
.p2align 6
.amdhsa_kernel standalone__autoregressive_conv_wavernn__speech_kernel
  .amdhsa_next_free_vgpr 512
  .amdhsa_next_free_sgpr 102
  .amdhsa_accum_offset 256
  .amdhsa_group_segment_fixed_size 0
  .amdhsa_kernarg_size 40
  .amdhsa_user_sgpr_count 2
  .amdhsa_user_sgpr_kernarg_segment_ptr 1
  .amdhsa_system_sgpr_workgroup_id_x 1
  .amdhsa_float_denorm_mode_32 3
.end_amdhsa_kernel
```
